```python
import torch

def _softmax(x, axis=-1):
    return torch.softmax(x, dim=axis)
def _gelu(x):
    return torch.nn.functional.gelu(x, approximate="tanh")
def _silu(x):
    return torch.nn.functional.silu(x)
def _sigmoid(x):
    return torch.sigmoid(x)
def _layernorm(x, axis=-1, eps=1e-5):
    m = x.mean(dim=axis, keepdim=True)
    v = x.var(dim=axis, keepdim=True, unbiased=False)
    return (x - m) / torch.sqrt(v + eps)
def _scatter_add(tgt, idx, src, axis=0):
    return tgt.clone().index_add_(axis, idx, src)
def _segment_sum(src, seg, n):
    out = torch.zeros((n,) + src.shape[1:], dtype=src.dtype)
    return out.index_add_(0, seg, src)
def _pad(x, pw):
    flat = tuple(v for pair in reversed(pw) for v in pair)
    return torch.nn.functional.pad(x, flat)

kernel_name = 'concat_heads__gqa_block_cached__gqa_block_cached__near_ridge'

def setup_inputs():

    _w = (lambda a: (lambda t: t.to(torch.bfloat16) if t.is_floating_point() else t)(torch.as_tensor(a)))
    def _A_setup():
        B, Sq, D = 8, 160, 640
        Hq, Hkv, Sk, Dh = 32, 32, 512, 128
        assert Hq % Hkv == 0, (Hq, Hkv)
        return {
            "x": _w((lambda *s: torch.randn(*s, dtype=torch.bfloat16) * 0.8)(B, Sq, D)),
            "k_cache": _w((lambda *s: torch.randn(*s, dtype=torch.bfloat16) * 0.8)(B, Hkv, Sk, Dh)),
            "v_cache": _w((lambda *s: torch.randn(*s, dtype=torch.bfloat16) * 0.05)(B, Hkv, Sk, Dh)),
            "wq": _w((lambda *s: torch.randn(*s, dtype=torch.bfloat16) * 0.8)(D, Hq * Dh) * (D ** -0.5)),
            "wo": _w((lambda *s: torch.randn(*s, dtype=torch.bfloat16) * 0.05)(Hq * Dh, D) * ((Hq * Dh) ** -0.5)),
        }
    _A_in = _A_setup()

    def _B_setup():
        B, Sq, D = 8, 160, 640
        Hq, Hkv, Sk, Dh = 32, 32, 512, 128
        assert Hq % Hkv == 0, (Hq, Hkv)
        return {
            "x": _w((lambda *s: torch.randn(*s, dtype=torch.bfloat16) * 0.8)(B, Sq, D)),
            "k_cache": _w((lambda *s: torch.randn(*s, dtype=torch.bfloat16) * 0.8)(B, Hkv, Sk, Dh)),
            "v_cache": _w((lambda *s: torch.randn(*s, dtype=torch.bfloat16) * 0.05)(B, Hkv, Sk, Dh)),
            "wq": _w((lambda *s: torch.randn(*s, dtype=torch.bfloat16) * 0.8)(D, Hq * Dh) * (D ** -0.5)),
            "wo": _w((lambda *s: torch.randn(*s, dtype=torch.bfloat16) * 0.05)(Hq * Dh, D) * ((Hq * Dh) ** -0.5)),
        }
    _B_in = _B_setup()

    return {
        "A_x": _A_in["x"],
        "A_k_cache": _A_in["k_cache"],
        "A_v_cache": _A_in["v_cache"],
        "A_wq": _A_in["wq"],
        "A_wo": _A_in["wo"],
        "B_x": _B_in["x"],
        "B_k_cache": _B_in["k_cache"],
        "B_v_cache": _B_in["v_cache"],
        "B_wq": _B_in["wq"],
        "B_wo": _B_in["wo"],
    }

def reference(A_x, A_k_cache, A_v_cache, A_wq, A_wo, B_x, B_k_cache, B_v_cache, B_wq, B_wo):
    def _A_ref(x, k_cache, v_cache, wq, wo):
        B, Sq, D = x.shape
        Hq, Dh = 32, 128
        Hkv = k_cache.shape[1]
        rep = Hq // Hkv
        q = (lambda x, *d: x.permute(*d))((x @ wq).reshape(B, Sq, Hq, Dh), 0, 2, 1, 3)
        k = (lambda x, n, axis: torch.repeat_interleave(x, n, dim=axis))(k_cache, rep, axis=1)
        v = (lambda x, n, axis: torch.repeat_interleave(x, n, dim=axis))(v_cache, rep, axis=1)
        scores = torch.einsum("bhqd,bhkd->bhqk", q, k) * (Dh ** -0.5)
        p = _softmax(scores, axis=-1)
        o = torch.einsum("bhqk,bhkd->bhqd", p, v)
        return (lambda x, *d: x.permute(*d))(o, 0, 2, 1, 3).reshape(B, Sq, Hq * Dh) @ wo

    def _B_ref(x, k_cache, v_cache, wq, wo):
        B, Sq, D = x.shape
        Hq, Dh = 32, 128
        Hkv = k_cache.shape[1]
        rep = Hq // Hkv
        q = (lambda x, *d: x.permute(*d))((x @ wq).reshape(B, Sq, Hq, Dh), 0, 2, 1, 3)
        k = (lambda x, n, axis: torch.repeat_interleave(x, n, dim=axis))(k_cache, rep, axis=1)
        v = (lambda x, n, axis: torch.repeat_interleave(x, n, dim=axis))(v_cache, rep, axis=1)
        scores = torch.einsum("bhqd,bhkd->bhqk", q, k) * (Dh ** -0.5)
        p = _softmax(scores, axis=-1)
        o = torch.einsum("bhqk,bhkd->bhqd", p, v)
        return (lambda x, *d: x.permute(*d))(o, 0, 2, 1, 3).reshape(B, Sq, Hq * Dh) @ wo

    a = _A_ref(A_x, A_k_cache, A_v_cache, A_wq, A_wo)
    b = _B_ref(B_x, B_k_cache, B_v_cache, B_wq, B_wo)
    return torch.concatenate([a, b], axis=-1)
```

```asm
; @launch grid=(256,1,1) block=(256,1,1) lds=163840
.amdgcn_target "amdgcn-amd-amdhsa--gfx950"
.text
.globl concat_heads__gqa_block_cached__gqa_block_cached__near_ridge_kernel
.p2align 8
.type concat_heads__gqa_block_cached__gqa_block_cached__near_ridge_kernel,@function
concat_heads__gqa_block_cached__gqa_block_cached__near_ridge_kernel:
    s_cmp_ge_u32 s2, 256
    s_cbranch_scc1 L_END
    s_load_dwordx2 s[16:17], s[0:1], 0
    s_load_dwordx2 s[18:19], s[0:1], 40
    s_load_dwordx2 s[20:21], s[0:1], 8
    s_load_dwordx2 s[22:23], s[0:1], 48
    s_load_dwordx2 s[24:25], s[0:1], 16
    s_load_dwordx2 s[26:27], s[0:1], 56
    s_load_dwordx2 s[28:29], s[0:1], 24
    s_load_dwordx2 s[30:31], s[0:1], 64
    s_load_dwordx2 s[32:33], s[0:1], 32
    s_load_dwordx2 s[34:35], s[0:1], 72
    s_load_dwordx2 s[36:37], s[0:1], 80
    s_load_dwordx2 s[40:41], s[0:1], 88
    s_load_dwordx2 s[96:97], s[0:1], 96
    v_lshrrev_b32 v4, 6, v0
    v_and_b32 v1, 63, v0
    v_readfirstlane_b32 s48, v4
    v_lshrrev_b32 v2, 4, v1
    v_and_b32 v3, 15, v1
    v_lshlrev_b32 v12, 4, v1
    s_and_b32 s49, s48, 1
    s_lshr_b32 s50, s48, 1
    s_and_b32 s70, s2, 7
    s_lshr_b32 s101, s2, 3
    s_lshr_b32 s67, s70, 2
    s_and_b32 s70, s70, 3
    s_and_b32 s68, s101, 7
    s_lshr_b32 s71, s101, 3
    s_lshl_b32 s51, s70, 3
    s_lshl_b32 s52, s71, 1
    s_add_u32 s3, s51, s52
    v_lshrrev_b32 v4, 3, v1
    v_mul_u32_u24 v4, 1280, v4
    v_and_b32 v5, 7, v1
    v_xor_b32 v5, v5, v2
    s_lshl_b32 s51, s49, 2
    v_xor_b32 v5, s51, v5
    v_xor_b32 v6, 0, v5
    v_lshl_add_u32 v6, v6, 4, v4
    v_xor_b32 v7, 4, v5
    v_lshl_add_u32 v7, v7, 4, v4
    v_lshlrev_b32 v5, 1, v2
    v_xor_b32 v5, v5, v3
    v_lshlrev_b32 v4, 13, v2
    v_xor_b32 v8, 0, v5
    v_lshl_add_u32 v8, v8, 4, v4
    v_xor_b32 v9, 8, v5
    v_lshl_add_u32 v9, v9, 4, v4
    v_lshlrev_b32 v4, 8, v2
    v_xor_b32 v10, 0, v5
    v_lshl_add_u32 v10, v10, 4, v4
    v_xor_b32 v11, 8, v5
    v_lshl_add_u32 v11, v11, 4, v4
    v_lshlrev_b32 v35, 7, v1
    v_lshrrev_b32 v4, 2, v1
    v_lshlrev_b32 v4, 16, v4
    v_and_b32 v5, 3, v1
    v_lshl_add_u32 v36, v5, 7, v4
    s_mul_i32 s55, s48, 51200
    s_mul_i32 s65, s48, 5120
    s_add_u32 s51, s3, s50
    s_lshl_b32 s51, s51, 8
    s_lshl_b32 s52, s49, 18
    s_add_u32 s56, s51, s52
    s_lshl_b32 s51, s50, 14
    s_lshl_b32 s52, s49, 13
    s_add_u32 s66, s51, s52
    s_mul_i32 s51, s71, 5
    s_lshr_b32 s51, s51, 1
    s_add_u32 s81, s51, s68
    s_cmp_ge_u32 s81, 10
    s_cselect_b32 s51, 10, 0
    s_sub_u32 s81, s81, s51
    s_lshl_b32 s52, s81, 7
    s_add_u32 s55, s55, s52
    s_lshl_b32 s52, s81, 19
    s_add_u32 s56, s56, s52
    s_waitcnt lgkmcnt(0)
    s_cmp_eq_u32 s67, 0
    s_cselect_b64 s[16:17], s[16:17], s[18:19]
    s_cselect_b64 s[20:21], s[20:21], s[22:23]
    s_cselect_b64 s[24:25], s[24:25], s[26:27]
    s_cselect_b64 s[28:29], s[28:29], s[30:31]
    s_cselect_b64 s[32:33], s[32:33], s[34:35]
    s_mul_i32 s51, s68, 204800
    s_add_u32 s16, s16, s51
    s_addc_u32 s17, s17, 0
    s_mov_b32 s8, s16
    s_mov_b32 s9, s17
    s_mov_b32 s10, 204800
    s_mov_b32 s11, 131072
    s_mov_b32 s12, s28
    s_mov_b32 s13, s29
    s_mov_b32 s14, 5242880
    s_mov_b32 s15, 131072
    s_add_u32 m0, s66, 32768
    s_add_u32 s51, s56, 0
    buffer_load_dwordx4 v8, s[12:15], s51 offen offset:0 lds
    s_add_u32 s51, s56, 31744
    buffer_load_dwordx4 v8, s[12:15], s51 offen offset:1024 lds
    s_add_u32 s51, s56, 63488
    buffer_load_dwordx4 v9, s[12:15], s51 offen offset:2048 lds
    s_add_u32 s51, s56, 95232
    buffer_load_dwordx4 v9, s[12:15], s51 offen offset:3072 lds
    s_add_u32 m0, s66, 36864
    s_add_u32 s51, s56, 131072
    buffer_load_dwordx4 v8, s[12:15], s51 offen offset:0 lds
    s_add_u32 s51, s56, 162816
    buffer_load_dwordx4 v8, s[12:15], s51 offen offset:1024 lds
    s_add_u32 s51, s56, 194560
    buffer_load_dwordx4 v9, s[12:15], s51 offen offset:2048 lds
    s_add_u32 s51, s56, 226304
    buffer_load_dwordx4 v9, s[12:15], s51 offen offset:3072 lds
    s_add_u32 m0, s65, 65536
    s_add_u32 s51, s55, 0
    buffer_load_dwordx4 v6, s[8:11], s51 offen offset:0 lds
    s_add_u32 s51, s55, 9216
    buffer_load_dwordx4 v7, s[8:11], s51 offen offset:1024 lds
    s_add_u32 s51, s55, 18432
    buffer_load_dwordx4 v6, s[8:11], s51 offen offset:2048 lds
    s_add_u32 s51, s55, 27648
    buffer_load_dwordx4 v7, s[8:11], s51 offen offset:3072 lds
    s_add_u32 m0, s65, 69632
    s_add_u32 s51, s55, 40960
    buffer_load_dwordx4 v6, s[8:11], s51 offen offset:0 lds
    s_add_u32 s81, s81, 1
    s_cmp_eq_u32 s81, 10
    s_cselect_b32 s81, 0, s81
    s_cselect_b32 s51, -9, 1
    s_lshl_b32 s52, s51, 7
    s_add_u32 s55, s55, s52
    s_lshl_b32 s52, s51, 19
    s_add_u32 s56, s56, s52
    s_getpc_b64 s[98:99]
L_PC0:
    s_and_b32 s51, s101, 1
    s_lshl_b32 s51, s51, 2
    s_add_u32 s51, s51, s48
    s_min_u32 s51, s51, 4
    s_lshl_b32 s51, s51, 13
    v_add_u32 v4, s51, v35
    v_min_u32 v4, (L_TEXT_END-L_PC0-4), v4
    global_load_dword v37, v4, s[98:99]
    s_lshl_b32 s51, s68, 5
    s_add_u32 s51, s51, s3
    s_lshl_b32 s51, s51, 17
    s_add_u32 s98, s24, s51
    s_addc_u32 s99, s25, 0
    s_add_u32 s16, s20, s51
    s_addc_u32 s17, s21, 0
    s_mov_b32 s18, 262144
    s_mov_b32 s19, 131072
    s_mov_b32 s20, s98
    s_mov_b32 s21, s99
    s_mov_b32 s22, 262144
    s_mov_b32 s23, 131072
    s_mov_b32 s28, s32
    s_mov_b32 s29, s33
    s_mov_b32 s30, 5242880
    s_mov_b32 s31, 131072
    s_mul_i32 s51, s67, 10485760
    s_add_u32 s98, s96, s51
    s_addc_u32 s99, s97, 0
    s_mov_b32 s24, s98
    s_mov_b32 s25, s99
    s_mov_b32 s26, 10485760
    s_mov_b32 s27, 131072
    s_mov_b32 s32, s96
    s_mov_b32 s33, s97
    s_mov_b32 s34, 268435456
    s_mov_b32 s35, 131072
    s_mov_b32 s42, 256
    s_mov_b32 s43, 131072
    s_lshl_b32 s51, s68, 1
    s_and_b32 s52, s70, 1
    s_add_u32 s51, s51, s52
    s_mul_i32 s51, s51, 204800
    s_lshl_b32 s52, s71, 1
    s_lshr_b32 s53, s70, 1
    s_add_u32 s52, s52, s53
    s_mul_i32 s52, s52, 160
    s_add_u32 s51, s51, s52
    s_mul_i32 s52, s67, 1280
    s_add_u32 s51, s51, s52
    s_add_u32 s36, s36, s51
    s_addc_u32 s37, s37, 0
    s_mov_b32 s38, 202400
    s_mov_b32 s39, 131072
    s_lshl_b32 s51, s67, 2
    s_add_u32 s51, s51, s70
    s_lshl_b32 s51, s51, 3
    s_add_u32 s51, s51, s68
    s_lshl_b32 s83, s51, 2
    s_mov_b32 s69, 1040356334
    s_lshl_b32 s51, s50, 13
    s_lshl_b32 s52, s49, 12
    s_add_u32 s59, s51, s52
    s_lshl_b32 s51, s50, 17
    s_add_u32 s57, s51, s52
    s_mov_b32 s58, s57
    s_lshl_b32 s51, s68, 1
    s_add_u32 s51, s51, s49
    s_lshl_b32 s51, s51, 7
    s_add_u32 s52, s3, s50
    s_lshl_b32 s52, s52, 2
    s_add_u32 s52, s51, s52
    s_mul_i32 s61, s52, 5120
    s_lshl_b32 s54, s70, 5
    s_add_u32 s52, s51, s54
    s_mul_i32 s52, s52, 5120
    s_add_u32 s53, s54, s49
    s_mul_i32 s53, s53, 40960
    s_mul_i32 s54, s71, 320
    s_add_u32 s53, s53, s54
    s_cmp_lt_u32 s48, 2
    s_cselect_b32 s75, s52, s53
    s_cselect_b32 s51, 1, 8
    s_mul_i32 s62, s51, 10240
    s_cselect_b32 s51, 1, 4
    s_mul_i32 s82, s51, 5120
    s_cselect_b32 s44, s24, s28
    s_cselect_b32 s45, s25, s29
    s_cselect_b32 s46, s26, s30
    s_mov_b32 s47, 131072
    s_mul_i32 s76, s48, 10240
    s_cselect_b64 s[4:5], -1, 0
    v_add_u32 v4, 0, v1
    v_mul_u32_u24 v5, 3277, v4
    v_lshrrev_b32 v5, 16, v5
    v_mul_u32_u24 v38, 20, v5
    v_sub_u32 v38, v4, v38
    v_mul_u32_u24 v5, 1280, v5
    v_lshl_add_u32 v38, v38, 4, v5
    v_lshlrev_b32 v4, 4, v4
    v_cndmask_b32 v38, v38, v4, s[4:5]
    v_add_u32 v4, 64, v1
    v_mul_u32_u24 v5, 3277, v4
    v_lshrrev_b32 v5, 16, v5
    v_mul_u32_u24 v39, 20, v5
    v_sub_u32 v39, v4, v39
    v_mul_u32_u24 v5, 1280, v5
    v_lshl_add_u32 v39, v39, 4, v5
    v_lshlrev_b32 v4, 4, v4
    v_cndmask_b32 v39, v39, v4, s[4:5]
    v_add_u32 v4, 128, v1
    v_mul_u32_u24 v5, 3277, v4
    v_lshrrev_b32 v5, 16, v5
    v_mul_u32_u24 v40, 20, v5
    v_sub_u32 v40, v4, v40
    v_mul_u32_u24 v5, 1280, v5
    v_lshl_add_u32 v40, v40, 4, v5
    v_lshlrev_b32 v4, 4, v4
    v_cndmask_b32 v40, v40, v4, s[4:5]
    v_add_u32 v4, 192, v1
    v_mul_u32_u24 v5, 3277, v4
    v_lshrrev_b32 v5, 16, v5
    v_mul_u32_u24 v41, 20, v5
    v_sub_u32 v41, v4, v41
    v_mul_u32_u24 v5, 1280, v5
    v_lshl_add_u32 v41, v41, 4, v5
    v_lshlrev_b32 v4, 4, v4
    v_cndmask_b32 v41, v41, v4, s[4:5]
    v_add_u32 v4, 256, v1
    v_mul_u32_u24 v5, 3277, v4
    v_lshrrev_b32 v5, 16, v5
    v_mul_u32_u24 v42, 20, v5
    v_sub_u32 v42, v4, v42
    v_mul_u32_u24 v5, 1280, v5
    v_lshl_add_u32 v42, v42, 4, v5
    v_lshlrev_b32 v4, 4, v4
    v_cndmask_b32 v42, v42, v4, s[4:5]
    s_lshl_b32 s51, s101, 2
    s_add_u32 s51, s51, s48
    s_mul_i32 s52, s70, 1310720
    s_lshl_b32 s53, s51, 13
    s_add_u32 s91, s52, s53
    s_add_u32 s52, s91, 1048576
    s_cmp_lt_u32 s51, 32
    s_cselect_b32 s92, s52, 2130706432
    s_mul_i32 s51, s49, 80
    v_add_u32 v4, s51, v3
    v_lshlrev_b32 v4, 7, v4
    v_add_u32 v4, 65536, v4
    v_lshrrev_b32 v5, 1, v3
    v_xor_b32 v5, v5, v2
    v_xor_b32 v13, 0, v5
    v_lshl_add_u32 v13, v13, 4, v4
    v_xor_b32 v14, 4, v5
    v_lshl_add_u32 v14, v14, 4, v4
    v_lshrrev_b32 v224, 2, v3
    v_and_b32 v225, 1, v2
    v_lshl_or_b32 v225, v225, 2, v224
    v_and_b32 v5, 3, v3
    v_lshl_add_u32 v4, v2, 3, v224
    v_lshlrev_b32 v4, 8, v4
    v_lshl_add_u32 v4, v5, 3, v4
    s_lshl_b32 s51, s50, 14
    s_add_u32 s51, s51, 32768
    v_add_u32 v4, s51, v4
    v_xor_b32 v15, 0, v225
    v_lshl_add_u32 v15, v15, 5, v4
    v_xor_b32 v16, 1, v225
    v_lshl_add_u32 v16, v16, 5, v4
    v_xor_b32 v17, 2, v225
    v_lshl_add_u32 v17, v17, 5, v4
    v_xor_b32 v18, 3, v225
    v_lshl_add_u32 v18, v18, 5, v4
    v_xor_b32 v19, 4, v225
    v_lshl_add_u32 v19, v19, 5, v4
    v_xor_b32 v20, 5, v225
    v_lshl_add_u32 v20, v20, 5, v4
    v_xor_b32 v21, 6, v225
    v_lshl_add_u32 v21, v21, 5, v4
    v_xor_b32 v22, 7, v225
    v_lshl_add_u32 v22, v22, 5, v4
    s_lshl_b32 s51, s50, 13
    v_lshl_add_u32 v4, v2, 2, v224
    v_lshlrev_b32 v4, 8, v4
    v_lshl_add_u32 v4, v5, 3, v4
    s_add_u32 s52, s51, 147456
    v_add_u32 v4, s52, v4
    v_xor_b32 v27, 0, v225
    v_lshl_add_u32 v27, v27, 5, v4
    v_xor_b32 v28, 1, v225
    v_lshl_add_u32 v28, v28, 5, v4
    v_xor_b32 v29, 2, v225
    v_lshl_add_u32 v29, v29, 5, v4
    v_xor_b32 v30, 3, v225
    v_lshl_add_u32 v30, v30, 5, v4
    v_xor_b32 v31, 4, v225
    v_lshl_add_u32 v31, v31, 5, v4
    v_xor_b32 v32, 5, v225
    v_lshl_add_u32 v32, v32, 5, v4
    v_xor_b32 v33, 6, v225
    v_lshl_add_u32 v33, v33, 5, v4
    v_xor_b32 v34, 7, v225
    v_lshl_add_u32 v34, v34, 5, v4
    v_lshlrev_b32 v4, 8, v3
    v_add_u32 v4, s51, v4
    v_and_b32 v5, 7, v3
    v_lshlrev_b32 v5, 1, v5
    v_xor_b32 v5, v5, v2
    v_xor_b32 v23, 0, v5
    v_lshl_add_u32 v23, v23, 4, v4
    v_xor_b32 v24, 4, v5
    v_lshl_add_u32 v24, v24, 4, v4
    v_xor_b32 v25, 8, v5
    v_lshl_add_u32 v25, v25, 4, v4
    v_xor_b32 v26, 12, v5
    v_lshl_add_u32 v26, v26, 4, v4
    s_lshl_b32 s51, s67, 3
    s_add_u32 s51, s51, s68
    s_lshl_b32 s51, s51, 2
    s_add_u32 s51, s51, s71
    s_lshl_b32 s63, s51, 2
    s_waitcnt vmcnt(1)
    s_barrier
    ds_read_b128 a[64:67], v13 offset:0
    ds_read_b128 a[68:71], v13 offset:2048
    ds_read_b128 a[72:75], v13 offset:4096
    ds_read_b128 a[76:79], v13 offset:6144
    ds_read_b128 a[80:83], v13 offset:8192
    ds_read_b64_tr_b16 a[0:1], v15 offset:0
    ds_read_b64_tr_b16 a[2:3], v15 offset:1024
    ds_read_b64_tr_b16 a[4:5], v16 offset:0
    ds_read_b64_tr_b16 a[6:7], v16 offset:1024
    ds_read_b64_tr_b16 a[8:9], v17 offset:0
    ds_read_b64_tr_b16 a[10:11], v17 offset:1024
    ds_read_b64_tr_b16 a[12:13], v18 offset:0
    ds_read_b64_tr_b16 a[14:15], v18 offset:1024
    ds_read_b64_tr_b16 a[16:17], v19 offset:0
    ds_read_b64_tr_b16 a[18:19], v19 offset:1024
    ds_read_b64_tr_b16 a[20:21], v20 offset:0
    ds_read_b64_tr_b16 a[22:23], v20 offset:1024
    ds_read_b64_tr_b16 a[24:25], v21 offset:0
    ds_read_b64_tr_b16 a[26:27], v21 offset:1024
    ds_read_b64_tr_b16 a[28:29], v22 offset:0
    ds_read_b64_tr_b16 a[30:31], v22 offset:1024
    ds_read_b128 a[84:87], v14 offset:0
    ds_read_b128 a[88:91], v14 offset:2048
    ds_read_b128 a[92:95], v14 offset:4096
    ds_read_b128 a[96:99], v14 offset:6144
    ds_read_b128 a[100:103], v14 offset:8192
    ds_read_b64_tr_b16 a[32:33], v15 offset:8192
    ds_read_b64_tr_b16 a[34:35], v15 offset:9216
    ds_read_b64_tr_b16 a[36:37], v16 offset:8192
    ds_read_b64_tr_b16 a[38:39], v16 offset:9216
    ds_read_b64_tr_b16 a[40:41], v17 offset:8192
    ds_read_b64_tr_b16 a[42:43], v17 offset:9216
    ds_read_b64_tr_b16 a[44:45], v18 offset:8192
    ds_read_b64_tr_b16 a[46:47], v18 offset:9216
    ds_read_b64_tr_b16 a[48:49], v19 offset:8192
    ds_read_b64_tr_b16 a[50:51], v19 offset:9216
    ds_read_b64_tr_b16 a[52:53], v20 offset:8192
    ds_read_b64_tr_b16 a[54:55], v20 offset:9216
    ds_read_b64_tr_b16 a[56:57], v21 offset:8192
    ds_read_b64_tr_b16 a[58:59], v21 offset:9216
    ds_read_b64_tr_b16 a[60:61], v22 offset:8192
    ds_read_b64_tr_b16 a[62:63], v22 offset:9216
    s_mov_b32 s60, 0
    s_waitcnt lgkmcnt(15)
    v_mfma_f32_16x16x32_bf16 v[48:51], a[0:3], a[64:67], 0
    s_add_u32 m0, s66, 86016
    s_add_u32 s51, s56, 0
    buffer_load_dwordx4 v8, s[12:15], s51 offen offset:0 lds
    v_mfma_f32_16x16x32_bf16 v[80:83], a[0:3], a[68:71], 0
    s_add_u32 s51, s56, 31744
    buffer_load_dwordx4 v8, s[12:15], s51 offen offset:1024 lds
    v_mfma_f32_16x16x32_bf16 v[112:115], a[0:3], a[72:75], 0
    v_mfma_f32_16x16x32_bf16 v[144:147], a[0:3], a[76:79], 0
    s_add_u32 s51, s56, 63488
    buffer_load_dwordx4 v9, s[12:15], s51 offen offset:2048 lds
    v_mfma_f32_16x16x32_bf16 v[176:179], a[0:3], a[80:83], 0
    s_add_u32 s51, s56, 95232
    buffer_load_dwordx4 v9, s[12:15], s51 offen offset:3072 lds
    v_mfma_f32_16x16x32_bf16 v[52:55], a[4:7], a[64:67], 0
    v_mfma_f32_16x16x32_bf16 v[84:87], a[4:7], a[68:71], 0
    s_add_u32 m0, s66, 90112
    s_add_u32 s51, s56, 131072
    buffer_load_dwordx4 v8, s[12:15], s51 offen offset:0 lds
    v_mfma_f32_16x16x32_bf16 v[116:119], a[4:7], a[72:75], 0
    s_add_u32 s51, s56, 162816
    buffer_load_dwordx4 v8, s[12:15], s51 offen offset:1024 lds
    v_mfma_f32_16x16x32_bf16 v[148:151], a[4:7], a[76:79], 0
    s_waitcnt lgkmcnt(0)
    s_barrier
    v_mfma_f32_16x16x32_bf16 v[180:183], a[4:7], a[80:83], 0
    s_add_u32 s51, s56, 194560
    buffer_load_dwordx4 v9, s[12:15], s51 offen offset:2048 lds
    v_mfma_f32_16x16x32_bf16 v[56:59], a[8:11], a[64:67], 0
    s_add_u32 s51, s56, 226304
    buffer_load_dwordx4 v9, s[12:15], s51 offen offset:3072 lds
    v_mfma_f32_16x16x32_bf16 v[88:91], a[8:11], a[68:71], 0
    v_mfma_f32_16x16x32_bf16 v[120:123], a[8:11], a[72:75], 0
    s_add_u32 m0, s65, 118784
    s_add_u32 s51, s55, 0
    buffer_load_dwordx4 v6, s[8:11], s51 offen offset:0 lds
    v_mfma_f32_16x16x32_bf16 v[152:155], a[8:11], a[76:79], 0
    s_add_u32 s51, s55, 9216
    buffer_load_dwordx4 v7, s[8:11], s51 offen offset:1024 lds
    v_mfma_f32_16x16x32_bf16 v[184:187], a[8:11], a[80:83], 0
    v_mfma_f32_16x16x32_bf16 v[60:63], a[12:15], a[64:67], 0
    s_add_u32 s51, s55, 18432
    buffer_load_dwordx4 v6, s[8:11], s51 offen offset:2048 lds
    v_mfma_f32_16x16x32_bf16 v[92:95], a[12:15], a[68:71], 0
    s_add_u32 s51, s55, 27648
    buffer_load_dwordx4 v7, s[8:11], s51 offen offset:3072 lds
    v_mfma_f32_16x16x32_bf16 v[124:127], a[12:15], a[72:75], 0
    v_mfma_f32_16x16x32_bf16 v[156:159], a[12:15], a[76:79], 0
    s_add_u32 m0, s65, 122880
    s_add_u32 s51, s55, 40960
    buffer_load_dwordx4 v6, s[8:11], s51 offen offset:0 lds
    v_mfma_f32_16x16x32_bf16 v[188:191], a[12:15], a[80:83], 0
    s_add_u32 s81, s81, 1
    s_cmp_eq_u32 s81, 10
    s_cselect_b32 s81, 0, s81
    s_cselect_b32 s51, -9, 1
    s_lshl_b32 s52, s51, 7
    s_add_u32 s55, s55, s52
    s_lshl_b32 s52, s51, 19
    s_add_u32 s56, s56, s52
    v_mfma_f32_16x16x32_bf16 v[64:67], a[16:19], a[64:67], 0
    v_mfma_f32_16x16x32_bf16 v[96:99], a[16:19], a[68:71], 0
    s_add_u32 m0, s66, 32768
    s_add_u32 s51, s56, 0
    buffer_load_dwordx4 v8, s[12:15], s51 offen offset:0 lds
    v_mfma_f32_16x16x32_bf16 v[128:131], a[16:19], a[72:75], 0
    s_add_u32 s51, s56, 31744
    buffer_load_dwordx4 v8, s[12:15], s51 offen offset:1024 lds
    v_mfma_f32_16x16x32_bf16 v[160:163], a[16:19], a[76:79], 0
    v_mfma_f32_16x16x32_bf16 v[192:195], a[16:19], a[80:83], 0
    s_add_u32 s51, s56, 63488
    buffer_load_dwordx4 v9, s[12:15], s51 offen offset:2048 lds
    v_mfma_f32_16x16x32_bf16 v[68:71], a[20:23], a[64:67], 0
    s_add_u32 s51, s56, 95232
    buffer_load_dwordx4 v9, s[12:15], s51 offen offset:3072 lds
    v_mfma_f32_16x16x32_bf16 v[100:103], a[20:23], a[68:71], 0
    v_mfma_f32_16x16x32_bf16 v[132:135], a[20:23], a[72:75], 0
    s_add_u32 m0, s66, 36864
    s_add_u32 s51, s56, 131072
    buffer_load_dwordx4 v8, s[12:15], s51 offen offset:0 lds
    v_mfma_f32_16x16x32_bf16 v[164:167], a[20:23], a[76:79], 0
    s_add_u32 s51, s56, 162816
    buffer_load_dwordx4 v8, s[12:15], s51 offen offset:1024 lds
    v_mfma_f32_16x16x32_bf16 v[196:199], a[20:23], a[80:83], 0
    v_mfma_f32_16x16x32_bf16 v[72:75], a[24:27], a[64:67], 0
    s_add_u32 s51, s56, 194560
    buffer_load_dwordx4 v9, s[12:15], s51 offen offset:2048 lds
    v_mfma_f32_16x16x32_bf16 v[104:107], a[24:27], a[68:71], 0
    s_add_u32 s51, s56, 226304
    buffer_load_dwordx4 v9, s[12:15], s51 offen offset:3072 lds
    v_mfma_f32_16x16x32_bf16 v[136:139], a[24:27], a[72:75], 0
    v_mfma_f32_16x16x32_bf16 v[168:171], a[24:27], a[76:79], 0
    s_add_u32 m0, s65, 65536
    s_add_u32 s51, s55, 0
    buffer_load_dwordx4 v6, s[8:11], s51 offen offset:0 lds
    v_mfma_f32_16x16x32_bf16 v[200:203], a[24:27], a[80:83], 0
    s_add_u32 s51, s55, 9216
    buffer_load_dwordx4 v7, s[8:11], s51 offen offset:1024 lds
    v_mfma_f32_16x16x32_bf16 v[76:79], a[28:31], a[64:67], 0
    v_mfma_f32_16x16x32_bf16 v[108:111], a[28:31], a[68:71], 0
    s_add_u32 s51, s55, 18432
    buffer_load_dwordx4 v6, s[8:11], s51 offen offset:2048 lds
    v_mfma_f32_16x16x32_bf16 v[140:143], a[28:31], a[72:75], 0
    s_add_u32 s51, s55, 27648
    buffer_load_dwordx4 v7, s[8:11], s51 offen offset:3072 lds
    v_mfma_f32_16x16x32_bf16 v[172:175], a[28:31], a[76:79], 0
    v_mfma_f32_16x16x32_bf16 v[204:207], a[28:31], a[80:83], 0
    s_add_u32 m0, s65, 69632
    s_add_u32 s51, s55, 40960
    buffer_load_dwordx4 v6, s[8:11], s51 offen offset:0 lds
    v_mfma_f32_16x16x32_bf16 v[48:51], a[32:35], a[84:87], v[48:51]
    s_add_u32 s81, s81, 1
    s_cmp_eq_u32 s81, 10
    s_cselect_b32 s81, 0, s81
    s_cselect_b32 s51, -9, 1
    s_lshl_b32 s52, s51, 7
    s_add_u32 s55, s55, s52
    s_lshl_b32 s52, s51, 19
    s_add_u32 s56, s56, s52
    v_mfma_f32_16x16x32_bf16 v[80:83], a[32:35], a[88:91], v[80:83]
    v_mfma_f32_16x16x32_bf16 v[112:115], a[32:35], a[92:95], v[112:115]
    v_mfma_f32_16x16x32_bf16 v[144:147], a[32:35], a[96:99], v[144:147]
    v_mfma_f32_16x16x32_bf16 v[176:179], a[32:35], a[100:103], v[176:179]
    v_mfma_f32_16x16x32_bf16 v[52:55], a[36:39], a[84:87], v[52:55]
    s_waitcnt vmcnt(13)
    s_barrier
    v_mfma_f32_16x16x32_bf16 v[84:87], a[36:39], a[88:91], v[84:87]
    ds_read_b128 a[168:171], v13 offset:53248
    ds_read_b128 a[172:175], v13 offset:55296
    v_mfma_f32_16x16x32_bf16 v[116:119], a[36:39], a[92:95], v[116:119]
    ds_read_b128 a[176:179], v13 offset:57344
    v_mfma_f32_16x16x32_bf16 v[148:151], a[36:39], a[96:99], v[148:151]
    ds_read_b128 a[180:183], v13 offset:59392
    ds_read_b128 a[184:187], v13 offset:61440
    v_mfma_f32_16x16x32_bf16 v[180:183], a[36:39], a[100:103], v[180:183]
    ds_read_b64_tr_b16 a[104:105], v15 offset:53248
    v_mfma_f32_16x16x32_bf16 v[56:59], a[40:43], a[84:87], v[56:59]
    ds_read_b64_tr_b16 a[106:107], v15 offset:54272
    ds_read_b64_tr_b16 a[108:109], v16 offset:53248
    v_mfma_f32_16x16x32_bf16 v[88:91], a[40:43], a[88:91], v[88:91]
    ds_read_b64_tr_b16 a[110:111], v16 offset:54272
    v_mfma_f32_16x16x32_bf16 v[120:123], a[40:43], a[92:95], v[120:123]
    ds_read_b64_tr_b16 a[112:113], v17 offset:53248
    ds_read_b64_tr_b16 a[114:115], v17 offset:54272
    v_mfma_f32_16x16x32_bf16 v[152:155], a[40:43], a[96:99], v[152:155]
    ds_read_b64_tr_b16 a[116:117], v18 offset:53248
    v_mfma_f32_16x16x32_bf16 v[184:187], a[40:43], a[100:103], v[184:187]
    ds_read_b64_tr_b16 a[118:119], v18 offset:54272
    ds_read_b64_tr_b16 a[120:121], v19 offset:53248
    v_mfma_f32_16x16x32_bf16 v[60:63], a[44:47], a[84:87], v[60:63]
    ds_read_b64_tr_b16 a[122:123], v19 offset:54272
    v_mfma_f32_16x16x32_bf16 v[92:95], a[44:47], a[88:91], v[92:95]
    ds_read_b64_tr_b16 a[124:125], v20 offset:53248
    ds_read_b64_tr_b16 a[126:127], v20 offset:54272
    v_mfma_f32_16x16x32_bf16 v[124:127], a[44:47], a[92:95], v[124:127]
    ds_read_b64_tr_b16 a[128:129], v21 offset:53248
    v_mfma_f32_16x16x32_bf16 v[156:159], a[44:47], a[96:99], v[156:159]
    ds_read_b64_tr_b16 a[130:131], v21 offset:54272
    ds_read_b64_tr_b16 a[132:133], v22 offset:53248
    v_mfma_f32_16x16x32_bf16 v[188:191], a[44:47], a[100:103], v[188:191]
    ds_read_b64_tr_b16 a[134:135], v22 offset:54272
    v_mfma_f32_16x16x32_bf16 v[64:67], a[48:51], a[84:87], v[64:67]
    ds_read_b128 a[188:191], v14 offset:53248
    ds_read_b128 a[192:195], v14 offset:55296
    v_mfma_f32_16x16x32_bf16 v[96:99], a[48:51], a[88:91], v[96:99]
    ds_read_b128 a[196:199], v14 offset:57344
    v_mfma_f32_16x16x32_bf16 v[128:131], a[48:51], a[92:95], v[128:131]
    ds_read_b128 a[200:203], v14 offset:59392
    ds_read_b128 a[204:207], v14 offset:61440
    v_mfma_f32_16x16x32_bf16 v[160:163], a[48:51], a[96:99], v[160:163]
    ds_read_b64_tr_b16 a[136:137], v15 offset:61440
    v_mfma_f32_16x16x32_bf16 v[192:195], a[48:51], a[100:103], v[192:195]
    ds_read_b64_tr_b16 a[138:139], v15 offset:62464
    ds_read_b64_tr_b16 a[140:141], v16 offset:61440
    v_mfma_f32_16x16x32_bf16 v[68:71], a[52:55], a[84:87], v[68:71]
    ds_read_b64_tr_b16 a[142:143], v16 offset:62464
    v_mfma_f32_16x16x32_bf16 v[100:103], a[52:55], a[88:91], v[100:103]
    ds_read_b64_tr_b16 a[144:145], v17 offset:61440
    ds_read_b64_tr_b16 a[146:147], v17 offset:62464
    v_mfma_f32_16x16x32_bf16 v[132:135], a[52:55], a[92:95], v[132:135]
    ds_read_b64_tr_b16 a[148:149], v18 offset:61440
    v_mfma_f32_16x16x32_bf16 v[164:167], a[52:55], a[96:99], v[164:167]
    ds_read_b64_tr_b16 a[150:151], v18 offset:62464
    ds_read_b64_tr_b16 a[152:153], v19 offset:61440
    v_mfma_f32_16x16x32_bf16 v[196:199], a[52:55], a[100:103], v[196:199]
    ds_read_b64_tr_b16 a[154:155], v19 offset:62464
    v_mfma_f32_16x16x32_bf16 v[72:75], a[56:59], a[84:87], v[72:75]
    ds_read_b64_tr_b16 a[156:157], v20 offset:61440
    ds_read_b64_tr_b16 a[158:159], v20 offset:62464
    v_mfma_f32_16x16x32_bf16 v[104:107], a[56:59], a[88:91], v[104:107]
    ds_read_b64_tr_b16 a[160:161], v21 offset:61440
    v_mfma_f32_16x16x32_bf16 v[136:139], a[56:59], a[92:95], v[136:139]
    ds_read_b64_tr_b16 a[162:163], v21 offset:62464
    ds_read_b64_tr_b16 a[164:165], v22 offset:61440
    v_mfma_f32_16x16x32_bf16 v[168:171], a[56:59], a[96:99], v[168:171]
    ds_read_b64_tr_b16 a[166:167], v22 offset:62464
    v_mfma_f32_16x16x32_bf16 v[200:203], a[56:59], a[100:103], v[200:203]
    v_mfma_f32_16x16x32_bf16 v[76:79], a[60:63], a[84:87], v[76:79]
    v_mfma_f32_16x16x32_bf16 v[108:111], a[60:63], a[88:91], v[108:111]
    v_mfma_f32_16x16x32_bf16 v[140:143], a[60:63], a[92:95], v[140:143]
    s_waitcnt lgkmcnt(0)
    s_barrier
    v_mfma_f32_16x16x32_bf16 v[172:175], a[60:63], a[96:99], v[172:175]
    v_mfma_f32_16x16x32_bf16 v[204:207], a[60:63], a[100:103], v[204:207]
    v_mfma_f32_16x16x32_bf16 v[48:51], a[104:107], a[168:171], v[48:51]
    s_waitcnt vmcnt(0)
    s_barrier
    v_mfma_f32_16x16x32_bf16 v[80:83], a[104:107], a[172:175], v[80:83]
    ds_read_b128 a[64:67], v13 offset:0
    ds_read_b128 a[68:71], v13 offset:2048
    v_mfma_f32_16x16x32_bf16 v[112:115], a[104:107], a[176:179], v[112:115]
    s_add_u32 m0, s66, 86016
    s_add_u32 s51, s56, 0
    buffer_load_dwordx4 v8, s[12:15], s51 offen offset:0 lds
    v_mfma_f32_16x16x32_bf16 v[144:147], a[104:107], a[180:183], v[144:147]
    ds_read_b128 a[72:75], v13 offset:4096
    ds_read_b128 a[76:79], v13 offset:6144
    v_mfma_f32_16x16x32_bf16 v[176:179], a[104:107], a[184:187], v[176:179]
    s_add_u32 s51, s56, 31744
    buffer_load_dwordx4 v8, s[12:15], s51 offen offset:1024 lds
    v_mfma_f32_16x16x32_bf16 v[52:55], a[108:111], a[168:171], v[52:55]
    ds_read_b128 a[80:83], v13 offset:8192
    ds_read_b64_tr_b16 a[0:1], v15 offset:0
    v_mfma_f32_16x16x32_bf16 v[84:87], a[108:111], a[172:175], v[84:87]
    s_add_u32 s51, s56, 63488
    buffer_load_dwordx4 v9, s[12:15], s51 offen offset:2048 lds
    v_mfma_f32_16x16x32_bf16 v[116:119], a[108:111], a[176:179], v[116:119]
    ds_read_b64_tr_b16 a[2:3], v15 offset:1024
    ds_read_b64_tr_b16 a[4:5], v16 offset:0
    v_mfma_f32_16x16x32_bf16 v[148:151], a[108:111], a[180:183], v[148:151]
    s_add_u32 s51, s56, 95232
    buffer_load_dwordx4 v9, s[12:15], s51 offen offset:3072 lds
    v_mfma_f32_16x16x32_bf16 v[180:183], a[108:111], a[184:187], v[180:183]
    ds_read_b64_tr_b16 a[6:7], v16 offset:1024
    ds_read_b64_tr_b16 a[8:9], v17 offset:0
    v_mfma_f32_16x16x32_bf16 v[56:59], a[112:115], a[168:171], v[56:59]
    s_add_u32 m0, s66, 90112
    s_add_u32 s51, s56, 131072
    buffer_load_dwordx4 v8, s[12:15], s51 offen offset:0 lds
    v_mfma_f32_16x16x32_bf16 v[88:91], a[112:115], a[172:175], v[88:91]
    ds_read_b64_tr_b16 a[10:11], v17 offset:1024
    ds_read_b64_tr_b16 a[12:13], v18 offset:0
    v_mfma_f32_16x16x32_bf16 v[120:123], a[112:115], a[176:179], v[120:123]
    ds_read_b64_tr_b16 a[14:15], v18 offset:1024
    ds_read_b64_tr_b16 a[16:17], v19 offset:0
    v_mfma_f32_16x16x32_bf16 v[152:155], a[112:115], a[180:183], v[152:155]
    s_add_u32 s51, s56, 162816
    buffer_load_dwordx4 v8, s[12:15], s51 offen offset:1024 lds
    v_mfma_f32_16x16x32_bf16 v[184:187], a[112:115], a[184:187], v[184:187]
    ds_read_b64_tr_b16 a[18:19], v19 offset:1024
    ds_read_b64_tr_b16 a[20:21], v20 offset:0
    v_mfma_f32_16x16x32_bf16 v[60:63], a[116:119], a[168:171], v[60:63]
    ds_read_b64_tr_b16 a[22:23], v20 offset:1024
    ds_read_b64_tr_b16 a[24:25], v21 offset:0
    v_mfma_f32_16x16x32_bf16 v[92:95], a[116:119], a[172:175], v[92:95]
    s_add_u32 s51, s56, 194560
    buffer_load_dwordx4 v9, s[12:15], s51 offen offset:2048 lds
    v_mfma_f32_16x16x32_bf16 v[124:127], a[116:119], a[176:179], v[124:127]
    ds_read_b64_tr_b16 a[26:27], v21 offset:1024
    ds_read_b64_tr_b16 a[28:29], v22 offset:0
    v_mfma_f32_16x16x32_bf16 v[156:159], a[116:119], a[180:183], v[156:159]
    ds_read_b64_tr_b16 a[30:31], v22 offset:1024
    ds_read_b128 a[84:87], v14 offset:0
    s_add_u32 s51, s56, 226304
    buffer_load_dwordx4 v9, s[12:15], s51 offen offset:3072 lds
    v_mfma_f32_16x16x32_bf16 v[188:191], a[116:119], a[184:187], v[188:191]
    ds_read_b128 a[88:91], v14 offset:2048
    ds_read_b128 a[92:95], v14 offset:4096
    v_mfma_f32_16x16x32_bf16 v[64:67], a[120:123], a[168:171], v[64:67]
    ds_read_b128 a[96:99], v14 offset:6144
    ds_read_b128 a[100:103], v14 offset:8192
    s_add_u32 m0, s65, 118784
    s_add_u32 s51, s55, 0
    buffer_load_dwordx4 v6, s[8:11], s51 offen offset:0 lds
    v_mfma_f32_16x16x32_bf16 v[96:99], a[120:123], a[172:175], v[96:99]
    ds_read_b64_tr_b16 a[32:33], v15 offset:8192
    ds_read_b64_tr_b16 a[34:35], v15 offset:9216
    v_mfma_f32_16x16x32_bf16 v[128:131], a[120:123], a[176:179], v[128:131]
    ds_read_b64_tr_b16 a[36:37], v16 offset:8192
    ds_read_b64_tr_b16 a[38:39], v16 offset:9216
    s_add_u32 s51, s55, 9216
    buffer_load_dwordx4 v7, s[8:11], s51 offen offset:1024 lds
    v_mfma_f32_16x16x32_bf16 v[160:163], a[120:123], a[180:183], v[160:163]
    ds_read_b64_tr_b16 a[40:41], v17 offset:8192
    ds_read_b64_tr_b16 a[42:43], v17 offset:9216
    v_mfma_f32_16x16x32_bf16 v[192:195], a[120:123], a[184:187], v[192:195]
    ds_read_b64_tr_b16 a[44:45], v18 offset:8192
    ds_read_b64_tr_b16 a[46:47], v18 offset:9216
    s_add_u32 s51, s55, 18432
    buffer_load_dwordx4 v6, s[8:11], s51 offen offset:2048 lds
    v_mfma_f32_16x16x32_bf16 v[68:71], a[124:127], a[168:171], v[68:71]
    ds_read_b64_tr_b16 a[48:49], v19 offset:8192
    ds_read_b64_tr_b16 a[50:51], v19 offset:9216
    v_mfma_f32_16x16x32_bf16 v[100:103], a[124:127], a[172:175], v[100:103]
    ds_read_b64_tr_b16 a[52:53], v20 offset:8192
    ds_read_b64_tr_b16 a[54:55], v20 offset:9216
    s_add_u32 s51, s55, 27648
    buffer_load_dwordx4 v7, s[8:11], s51 offen offset:3072 lds
    v_mfma_f32_16x16x32_bf16 v[132:135], a[124:127], a[176:179], v[132:135]
    ds_read_b64_tr_b16 a[56:57], v21 offset:8192
    ds_read_b64_tr_b16 a[58:59], v21 offset:9216
    v_mfma_f32_16x16x32_bf16 v[164:167], a[124:127], a[180:183], v[164:167]
    ds_read_b64_tr_b16 a[60:61], v22 offset:8192
    ds_read_b64_tr_b16 a[62:63], v22 offset:9216
    s_add_u32 m0, s65, 122880
    s_add_u32 s51, s55, 40960
    buffer_load_dwordx4 v6, s[8:11], s51 offen offset:0 lds
    v_mfma_f32_16x16x32_bf16 v[196:199], a[124:127], a[184:187], v[196:199]
    s_add_u32 s81, s81, 1
    s_cmp_eq_u32 s81, 10
    s_cselect_b32 s81, 0, s81
    s_cselect_b32 s51, -9, 1
    s_lshl_b32 s52, s51, 7
    s_add_u32 s55, s55, s52
    s_lshl_b32 s52, s51, 19
    s_add_u32 s56, s56, s52
    v_mfma_f32_16x16x32_bf16 v[72:75], a[128:131], a[168:171], v[72:75]
    v_mfma_f32_16x16x32_bf16 v[104:107], a[128:131], a[172:175], v[104:107]
    v_mfma_f32_16x16x32_bf16 v[136:139], a[128:131], a[176:179], v[136:139]
    s_waitcnt lgkmcnt(0)
    s_barrier
    v_mfma_f32_16x16x32_bf16 v[168:171], a[128:131], a[180:183], v[168:171]
    s_add_u32 m0, s66, 32768
    s_add_u32 s51, s56, 0
    buffer_load_dwordx4 v8, s[12:15], s51 offen offset:0 lds
    v_mfma_f32_16x16x32_bf16 v[200:203], a[128:131], a[184:187], v[200:203]
    v_mfma_f32_16x16x32_bf16 v[76:79], a[132:135], a[168:171], v[76:79]
    v_mfma_f32_16x16x32_bf16 v[108:111], a[132:135], a[172:175], v[108:111]
    s_add_u32 s51, s56, 31744
    buffer_load_dwordx4 v8, s[12:15], s51 offen offset:1024 lds
    v_mfma_f32_16x16x32_bf16 v[140:143], a[132:135], a[176:179], v[140:143]
    v_mfma_f32_16x16x32_bf16 v[172:175], a[132:135], a[180:183], v[172:175]
    v_mfma_f32_16x16x32_bf16 v[204:207], a[132:135], a[184:187], v[204:207]
    s_add_u32 s51, s56, 63488
    buffer_load_dwordx4 v9, s[12:15], s51 offen offset:2048 lds
    v_mfma_f32_16x16x32_bf16 v[48:51], a[136:139], a[188:191], v[48:51]
    v_mfma_f32_16x16x32_bf16 v[80:83], a[136:139], a[192:195], v[80:83]
    v_mfma_f32_16x16x32_bf16 v[112:115], a[136:139], a[196:199], v[112:115]
    s_add_u32 s51, s56, 95232
    buffer_load_dwordx4 v9, s[12:15], s51 offen offset:3072 lds
    v_mfma_f32_16x16x32_bf16 v[144:147], a[136:139], a[200:203], v[144:147]
    v_mfma_f32_16x16x32_bf16 v[176:179], a[136:139], a[204:207], v[176:179]
    v_mfma_f32_16x16x32_bf16 v[52:55], a[140:143], a[188:191], v[52:55]
    s_add_u32 m0, s66, 36864
    s_add_u32 s51, s56, 131072
    buffer_load_dwordx4 v8, s[12:15], s51 offen offset:0 lds
    v_mfma_f32_16x16x32_bf16 v[84:87], a[140:143], a[192:195], v[84:87]
    v_mfma_f32_16x16x32_bf16 v[116:119], a[140:143], a[196:199], v[116:119]
    v_mfma_f32_16x16x32_bf16 v[148:151], a[140:143], a[200:203], v[148:151]
    v_mfma_f32_16x16x32_bf16 v[180:183], a[140:143], a[204:207], v[180:183]
    s_add_u32 s51, s56, 162816
    buffer_load_dwordx4 v8, s[12:15], s51 offen offset:1024 lds
    v_mfma_f32_16x16x32_bf16 v[56:59], a[144:147], a[188:191], v[56:59]
    v_mfma_f32_16x16x32_bf16 v[88:91], a[144:147], a[192:195], v[88:91]
    v_mfma_f32_16x16x32_bf16 v[120:123], a[144:147], a[196:199], v[120:123]
    s_add_u32 s51, s56, 194560
    buffer_load_dwordx4 v9, s[12:15], s51 offen offset:2048 lds
    v_mfma_f32_16x16x32_bf16 v[152:155], a[144:147], a[200:203], v[152:155]
    v_mfma_f32_16x16x32_bf16 v[184:187], a[144:147], a[204:207], v[184:187]
    v_mfma_f32_16x16x32_bf16 v[60:63], a[148:151], a[188:191], v[60:63]
    s_add_u32 s51, s56, 226304
    buffer_load_dwordx4 v9, s[12:15], s51 offen offset:3072 lds
    v_mfma_f32_16x16x32_bf16 v[92:95], a[148:151], a[192:195], v[92:95]
    v_mfma_f32_16x16x32_bf16 v[124:127], a[148:151], a[196:199], v[124:127]
    v_mfma_f32_16x16x32_bf16 v[156:159], a[148:151], a[200:203], v[156:159]
    s_add_u32 m0, s65, 65536
    s_add_u32 s51, s55, 0
    buffer_load_dwordx4 v6, s[8:11], s51 offen offset:0 lds
    v_mfma_f32_16x16x32_bf16 v[188:191], a[148:151], a[204:207], v[188:191]
    v_mfma_f32_16x16x32_bf16 v[64:67], a[152:155], a[188:191], v[64:67]
    v_mfma_f32_16x16x32_bf16 v[96:99], a[152:155], a[192:195], v[96:99]
    s_add_u32 s51, s55, 9216
    buffer_load_dwordx4 v7, s[8:11], s51 offen offset:1024 lds
    v_mfma_f32_16x16x32_bf16 v[128:131], a[152:155], a[196:199], v[128:131]
    v_mfma_f32_16x16x32_bf16 v[160:163], a[152:155], a[200:203], v[160:163]
    v_mfma_f32_16x16x32_bf16 v[192:195], a[152:155], a[204:207], v[192:195]
    v_mfma_f32_16x16x32_bf16 v[68:71], a[156:159], a[188:191], v[68:71]
    s_add_u32 s51, s55, 18432
    buffer_load_dwordx4 v6, s[8:11], s51 offen offset:2048 lds
    v_mfma_f32_16x16x32_bf16 v[100:103], a[156:159], a[192:195], v[100:103]
    v_mfma_f32_16x16x32_bf16 v[132:135], a[156:159], a[196:199], v[132:135]
    v_mfma_f32_16x16x32_bf16 v[164:167], a[156:159], a[200:203], v[164:167]
    s_add_u32 s51, s55, 27648
    buffer_load_dwordx4 v7, s[8:11], s51 offen offset:3072 lds
    v_mfma_f32_16x16x32_bf16 v[196:199], a[156:159], a[204:207], v[196:199]
    v_mfma_f32_16x16x32_bf16 v[72:75], a[160:163], a[188:191], v[72:75]
    v_mfma_f32_16x16x32_bf16 v[104:107], a[160:163], a[192:195], v[104:107]
    s_add_u32 m0, s65, 69632
    s_add_u32 s51, s55, 40960
    buffer_load_dwordx4 v6, s[8:11], s51 offen offset:0 lds
    v_mfma_f32_16x16x32_bf16 v[136:139], a[160:163], a[196:199], v[136:139]
    v_mfma_f32_16x16x32_bf16 v[168:171], a[160:163], a[200:203], v[168:171]
    v_mfma_f32_16x16x32_bf16 v[200:203], a[160:163], a[204:207], v[200:203]
    s_add_u32 s81, s81, 1
    s_cmp_eq_u32 s81, 10
    s_cselect_b32 s81, 0, s81
    s_cselect_b32 s51, -9, 1
    s_lshl_b32 s52, s51, 7
    s_add_u32 s55, s55, s52
    s_lshl_b32 s52, s51, 19
    s_add_u32 s56, s56, s52
    v_mfma_f32_16x16x32_bf16 v[76:79], a[164:167], a[188:191], v[76:79]
    v_mfma_f32_16x16x32_bf16 v[108:111], a[164:167], a[192:195], v[108:111]
    v_mfma_f32_16x16x32_bf16 v[140:143], a[164:167], a[196:199], v[140:143]
    v_mfma_f32_16x16x32_bf16 v[172:175], a[164:167], a[200:203], v[172:175]
    v_mfma_f32_16x16x32_bf16 v[204:207], a[164:167], a[204:207], v[204:207]
    s_mov_b32 s87, 0
    s_waitcnt lgkmcnt(0)
    s_nop 15
L_QL:
    v_mfma_f32_16x16x32_bf16 v[48:51], a[0:3], a[64:67], v[48:51]
    s_waitcnt vmcnt(13)
    s_barrier
    v_mfma_f32_16x16x32_bf16 v[80:83], a[0:3], a[68:71], v[80:83]
    ds_read_b128 a[168:171], v13 offset:53248
    ds_read_b128 a[172:175], v13 offset:55296
    v_mfma_f32_16x16x32_bf16 v[112:115], a[0:3], a[72:75], v[112:115]
    ds_read_b128 a[176:179], v13 offset:57344
    v_mfma_f32_16x16x32_bf16 v[144:147], a[0:3], a[76:79], v[144:147]
    ds_read_b128 a[180:183], v13 offset:59392
    ds_read_b128 a[184:187], v13 offset:61440
    v_mfma_f32_16x16x32_bf16 v[176:179], a[0:3], a[80:83], v[176:179]
    ds_read_b64_tr_b16 a[104:105], v15 offset:53248
    v_mfma_f32_16x16x32_bf16 v[52:55], a[4:7], a[64:67], v[52:55]
    ds_read_b64_tr_b16 a[106:107], v15 offset:54272
    ds_read_b64_tr_b16 a[108:109], v16 offset:53248
    v_mfma_f32_16x16x32_bf16 v[84:87], a[4:7], a[68:71], v[84:87]
    ds_read_b64_tr_b16 a[110:111], v16 offset:54272
    v_mfma_f32_16x16x32_bf16 v[116:119], a[4:7], a[72:75], v[116:119]
    ds_read_b64_tr_b16 a[112:113], v17 offset:53248
    ds_read_b64_tr_b16 a[114:115], v17 offset:54272
    v_mfma_f32_16x16x32_bf16 v[148:151], a[4:7], a[76:79], v[148:151]
    ds_read_b64_tr_b16 a[116:117], v18 offset:53248
    v_mfma_f32_16x16x32_bf16 v[180:183], a[4:7], a[80:83], v[180:183]
    ds_read_b64_tr_b16 a[118:119], v18 offset:54272
    ds_read_b64_tr_b16 a[120:121], v19 offset:53248
    v_mfma_f32_16x16x32_bf16 v[56:59], a[8:11], a[64:67], v[56:59]
    ds_read_b64_tr_b16 a[122:123], v19 offset:54272
    v_mfma_f32_16x16x32_bf16 v[88:91], a[8:11], a[68:71], v[88:91]
    ds_read_b64_tr_b16 a[124:125], v20 offset:53248
    ds_read_b64_tr_b16 a[126:127], v20 offset:54272
    v_mfma_f32_16x16x32_bf16 v[120:123], a[8:11], a[72:75], v[120:123]
    ds_read_b64_tr_b16 a[128:129], v21 offset:53248
    v_mfma_f32_16x16x32_bf16 v[152:155], a[8:11], a[76:79], v[152:155]
    ds_read_b64_tr_b16 a[130:131], v21 offset:54272
    ds_read_b64_tr_b16 a[132:133], v22 offset:53248
    v_mfma_f32_16x16x32_bf16 v[184:187], a[8:11], a[80:83], v[184:187]
    ds_read_b64_tr_b16 a[134:135], v22 offset:54272
    v_mfma_f32_16x16x32_bf16 v[60:63], a[12:15], a[64:67], v[60:63]
    ds_read_b128 a[188:191], v14 offset:53248
    ds_read_b128 a[192:195], v14 offset:55296
    v_mfma_f32_16x16x32_bf16 v[92:95], a[12:15], a[68:71], v[92:95]
    ds_read_b128 a[196:199], v14 offset:57344
    v_mfma_f32_16x16x32_bf16 v[124:127], a[12:15], a[72:75], v[124:127]
    ds_read_b128 a[200:203], v14 offset:59392
    ds_read_b128 a[204:207], v14 offset:61440
    v_mfma_f32_16x16x32_bf16 v[156:159], a[12:15], a[76:79], v[156:159]
    ds_read_b64_tr_b16 a[136:137], v15 offset:61440
    v_mfma_f32_16x16x32_bf16 v[188:191], a[12:15], a[80:83], v[188:191]
    ds_read_b64_tr_b16 a[138:139], v15 offset:62464
    ds_read_b64_tr_b16 a[140:141], v16 offset:61440
    v_mfma_f32_16x16x32_bf16 v[64:67], a[16:19], a[64:67], v[64:67]
    ds_read_b64_tr_b16 a[142:143], v16 offset:62464
    v_mfma_f32_16x16x32_bf16 v[96:99], a[16:19], a[68:71], v[96:99]
    ds_read_b64_tr_b16 a[144:145], v17 offset:61440
    ds_read_b64_tr_b16 a[146:147], v17 offset:62464
    v_mfma_f32_16x16x32_bf16 v[128:131], a[16:19], a[72:75], v[128:131]
    ds_read_b64_tr_b16 a[148:149], v18 offset:61440
    v_mfma_f32_16x16x32_bf16 v[160:163], a[16:19], a[76:79], v[160:163]
    ds_read_b64_tr_b16 a[150:151], v18 offset:62464
    ds_read_b64_tr_b16 a[152:153], v19 offset:61440
    v_mfma_f32_16x16x32_bf16 v[192:195], a[16:19], a[80:83], v[192:195]
    ds_read_b64_tr_b16 a[154:155], v19 offset:62464
    v_mfma_f32_16x16x32_bf16 v[68:71], a[20:23], a[64:67], v[68:71]
    ds_read_b64_tr_b16 a[156:157], v20 offset:61440
    ds_read_b64_tr_b16 a[158:159], v20 offset:62464
    v_mfma_f32_16x16x32_bf16 v[100:103], a[20:23], a[68:71], v[100:103]
    ds_read_b64_tr_b16 a[160:161], v21 offset:61440
    v_mfma_f32_16x16x32_bf16 v[132:135], a[20:23], a[72:75], v[132:135]
    ds_read_b64_tr_b16 a[162:163], v21 offset:62464
    ds_read_b64_tr_b16 a[164:165], v22 offset:61440
    v_mfma_f32_16x16x32_bf16 v[164:167], a[20:23], a[76:79], v[164:167]
    ds_read_b64_tr_b16 a[166:167], v22 offset:62464
    v_mfma_f32_16x16x32_bf16 v[196:199], a[20:23], a[80:83], v[196:199]
    v_mfma_f32_16x16x32_bf16 v[72:75], a[24:27], a[64:67], v[72:75]
    v_mfma_f32_16x16x32_bf16 v[104:107], a[24:27], a[68:71], v[104:107]
    v_mfma_f32_16x16x32_bf16 v[136:139], a[24:27], a[72:75], v[136:139]
    s_waitcnt lgkmcnt(0)
    s_barrier
    v_mfma_f32_16x16x32_bf16 v[168:171], a[24:27], a[76:79], v[168:171]
    s_add_u32 m0, s66, 86016
    s_add_u32 s51, s56, 0
    buffer_load_dwordx4 v8, s[12:15], s51 offen offset:0 lds
    v_mfma_f32_16x16x32_bf16 v[200:203], a[24:27], a[80:83], v[200:203]
    v_mfma_f32_16x16x32_bf16 v[76:79], a[28:31], a[64:67], v[76:79]
    s_add_u32 s51, s56, 31744
    buffer_load_dwordx4 v8, s[12:15], s51 offen offset:1024 lds
    v_mfma_f32_16x16x32_bf16 v[108:111], a[28:31], a[68:71], v[108:111]
    v_mfma_f32_16x16x32_bf16 v[140:143], a[28:31], a[72:75], v[140:143]
    s_add_u32 s51, s56, 63488
    buffer_load_dwordx4 v9, s[12:15], s51 offen offset:2048 lds
    v_mfma_f32_16x16x32_bf16 v[172:175], a[28:31], a[76:79], v[172:175]
    v_mfma_f32_16x16x32_bf16 v[204:207], a[28:31], a[80:83], v[204:207]
    s_add_u32 s51, s56, 95232
    buffer_load_dwordx4 v9, s[12:15], s51 offen offset:3072 lds
    v_mfma_f32_16x16x32_bf16 v[48:51], a[32:35], a[84:87], v[48:51]
    v_mfma_f32_16x16x32_bf16 v[80:83], a[32:35], a[88:91], v[80:83]
    s_add_u32 m0, s66, 90112
    s_add_u32 s51, s56, 131072
    buffer_load_dwordx4 v8, s[12:15], s51 offen offset:0 lds
    v_mfma_f32_16x16x32_bf16 v[112:115], a[32:35], a[92:95], v[112:115]
    v_mfma_f32_16x16x32_bf16 v[144:147], a[32:35], a[96:99], v[144:147]
    s_add_u32 s51, s56, 162816
    buffer_load_dwordx4 v8, s[12:15], s51 offen offset:1024 lds
    v_mfma_f32_16x16x32_bf16 v[176:179], a[32:35], a[100:103], v[176:179]
    v_mfma_f32_16x16x32_bf16 v[52:55], a[36:39], a[84:87], v[52:55]
    s_add_u32 s51, s56, 194560
    buffer_load_dwordx4 v9, s[12:15], s51 offen offset:2048 lds
    v_mfma_f32_16x16x32_bf16 v[84:87], a[36:39], a[88:91], v[84:87]
    v_mfma_f32_16x16x32_bf16 v[116:119], a[36:39], a[92:95], v[116:119]
    v_mfma_f32_16x16x32_bf16 v[148:151], a[36:39], a[96:99], v[148:151]
    s_add_u32 s51, s56, 226304
    buffer_load_dwordx4 v9, s[12:15], s51 offen offset:3072 lds
    v_mfma_f32_16x16x32_bf16 v[180:183], a[36:39], a[100:103], v[180:183]
    v_mfma_f32_16x16x32_bf16 v[56:59], a[40:43], a[84:87], v[56:59]
    s_add_u32 m0, s65, 118784
    s_add_u32 s51, s55, 0
    buffer_load_dwordx4 v6, s[8:11], s51 offen offset:0 lds
    v_mfma_f32_16x16x32_bf16 v[88:91], a[40:43], a[88:91], v[88:91]
    v_mfma_f32_16x16x32_bf16 v[120:123], a[40:43], a[92:95], v[120:123]
    s_add_u32 s51, s55, 9216
    buffer_load_dwordx4 v7, s[8:11], s51 offen offset:1024 lds
    v_mfma_f32_16x16x32_bf16 v[152:155], a[40:43], a[96:99], v[152:155]
    v_mfma_f32_16x16x32_bf16 v[184:187], a[40:43], a[100:103], v[184:187]
    s_add_u32 s51, s55, 18432
    buffer_load_dwordx4 v6, s[8:11], s51 offen offset:2048 lds
    v_mfma_f32_16x16x32_bf16 v[60:63], a[44:47], a[84:87], v[60:63]
    v_mfma_f32_16x16x32_bf16 v[92:95], a[44:47], a[88:91], v[92:95]
    s_add_u32 s51, s55, 27648
    buffer_load_dwordx4 v7, s[8:11], s51 offen offset:3072 lds
    v_mfma_f32_16x16x32_bf16 v[124:127], a[44:47], a[92:95], v[124:127]
    v_mfma_f32_16x16x32_bf16 v[156:159], a[44:47], a[96:99], v[156:159]
    s_add_u32 m0, s65, 122880
    s_add_u32 s51, s55, 40960
    buffer_load_dwordx4 v6, s[8:11], s51 offen offset:0 lds
    v_mfma_f32_16x16x32_bf16 v[188:191], a[44:47], a[100:103], v[188:191]
    v_mfma_f32_16x16x32_bf16 v[64:67], a[48:51], a[84:87], v[64:67]
    s_add_u32 s81, s81, 1
    s_cmp_eq_u32 s81, 10
    s_cselect_b32 s81, 0, s81
    s_cselect_b32 s51, -9, 1
    s_lshl_b32 s52, s51, 7
    s_add_u32 s55, s55, s52
    s_lshl_b32 s52, s51, 19
    s_add_u32 s56, s56, s52
    v_mfma_f32_16x16x32_bf16 v[96:99], a[48:51], a[88:91], v[96:99]
    v_mfma_f32_16x16x32_bf16 v[128:131], a[48:51], a[92:95], v[128:131]
    v_mfma_f32_16x16x32_bf16 v[160:163], a[48:51], a[96:99], v[160:163]
    s_add_u32 m0, s59, s87
    v_mfma_f32_16x16x32_bf16 v[192:195], a[48:51], a[100:103], v[192:195]
    v_mfma_f32_16x16x32_bf16 v[68:71], a[52:55], a[84:87], v[68:71]
    buffer_load_dwordx4 v10, s[16:19], s57 offen offset:0 nt lds
    v_mfma_f32_16x16x32_bf16 v[100:103], a[52:55], a[88:91], v[100:103]
    v_mfma_f32_16x16x32_bf16 v[132:135], a[52:55], a[92:95], v[132:135]
    buffer_load_dwordx4 v11, s[16:19], s57 offen offset:1024 nt lds
    v_mfma_f32_16x16x32_bf16 v[164:167], a[52:55], a[96:99], v[164:167]
    v_mfma_f32_16x16x32_bf16 v[196:199], a[52:55], a[100:103], v[196:199]
    buffer_load_dwordx4 v10, s[16:19], s57 offen offset:2048 nt lds
    v_mfma_f32_16x16x32_bf16 v[72:75], a[56:59], a[84:87], v[72:75]
    v_mfma_f32_16x16x32_bf16 v[104:107], a[56:59], a[88:91], v[104:107]
    buffer_load_dwordx4 v11, s[16:19], s57 offen offset:3072 nt lds
    v_mfma_f32_16x16x32_bf16 v[136:139], a[56:59], a[92:95], v[136:139]
    v_mfma_f32_16x16x32_bf16 v[168:171], a[56:59], a[96:99], v[168:171]
    s_add_u32 s57, s57, 8192
    v_mfma_f32_16x16x32_bf16 v[200:203], a[56:59], a[100:103], v[200:203]
    v_mfma_f32_16x16x32_bf16 v[76:79], a[60:63], a[84:87], v[76:79]
    s_add_u32 s87, s87, 16384
    v_mfma_f32_16x16x32_bf16 v[108:111], a[60:63], a[88:91], v[108:111]
    v_mfma_f32_16x16x32_bf16 v[140:143], a[60:63], a[92:95], v[140:143]
    v_mfma_f32_16x16x32_bf16 v[172:175], a[60:63], a[96:99], v[172:175]
    v_mfma_f32_16x16x32_bf16 v[204:207], a[60:63], a[100:103], v[204:207]
    v_mfma_f32_16x16x32_bf16 v[48:51], a[104:107], a[168:171], v[48:51]
    s_waitcnt vmcnt(17)
    s_barrier
    v_mfma_f32_16x16x32_bf16 v[80:83], a[104:107], a[172:175], v[80:83]
    ds_read_b128 a[64:67], v13 offset:0
    ds_read_b128 a[68:71], v13 offset:2048
    v_mfma_f32_16x16x32_bf16 v[112:115], a[104:107], a[176:179], v[112:115]
    ds_read_b128 a[72:75], v13 offset:4096
    v_mfma_f32_16x16x32_bf16 v[144:147], a[104:107], a[180:183], v[144:147]
    ds_read_b128 a[76:79], v13 offset:6144
    ds_read_b128 a[80:83], v13 offset:8192
    v_mfma_f32_16x16x32_bf16 v[176:179], a[104:107], a[184:187], v[176:179]
    ds_read_b64_tr_b16 a[0:1], v15 offset:0
    v_mfma_f32_16x16x32_bf16 v[52:55], a[108:111], a[168:171], v[52:55]
    ds_read_b64_tr_b16 a[2:3], v15 offset:1024
    ds_read_b64_tr_b16 a[4:5], v16 offset:0
    v_mfma_f32_16x16x32_bf16 v[84:87], a[108:111], a[172:175], v[84:87]
    ds_read_b64_tr_b16 a[6:7], v16 offset:1024
    v_mfma_f32_16x16x32_bf16 v[116:119], a[108:111], a[176:179], v[116:119]
    ds_read_b64_tr_b16 a[8:9], v17 offset:0
    ds_read_b64_tr_b16 a[10:11], v17 offset:1024
    v_mfma_f32_16x16x32_bf16 v[148:151], a[108:111], a[180:183], v[148:151]
    ds_read_b64_tr_b16 a[12:13], v18 offset:0
    v_mfma_f32_16x16x32_bf16 v[180:183], a[108:111], a[184:187], v[180:183]
    ds_read_b64_tr_b16 a[14:15], v18 offset:1024
    ds_read_b64_tr_b16 a[16:17], v19 offset:0
    v_mfma_f32_16x16x32_bf16 v[56:59], a[112:115], a[168:171], v[56:59]
    ds_read_b64_tr_b16 a[18:19], v19 offset:1024
    v_mfma_f32_16x16x32_bf16 v[88:91], a[112:115], a[172:175], v[88:91]
    ds_read_b64_tr_b16 a[20:21], v20 offset:0
    ds_read_b64_tr_b16 a[22:23], v20 offset:1024
    v_mfma_f32_16x16x32_bf16 v[120:123], a[112:115], a[176:179], v[120:123]
    ds_read_b64_tr_b16 a[24:25], v21 offset:0
    v_mfma_f32_16x16x32_bf16 v[152:155], a[112:115], a[180:183], v[152:155]
    ds_read_b64_tr_b16 a[26:27], v21 offset:1024
    ds_read_b64_tr_b16 a[28:29], v22 offset:0
    v_mfma_f32_16x16x32_bf16 v[184:187], a[112:115], a[184:187], v[184:187]
    ds_read_b64_tr_b16 a[30:31], v22 offset:1024
    v_mfma_f32_16x16x32_bf16 v[60:63], a[116:119], a[168:171], v[60:63]
    ds_read_b128 a[84:87], v14 offset:0
    ds_read_b128 a[88:91], v14 offset:2048
    v_mfma_f32_16x16x32_bf16 v[92:95], a[116:119], a[172:175], v[92:95]
    ds_read_b128 a[92:95], v14 offset:4096
    v_mfma_f32_16x16x32_bf16 v[124:127], a[116:119], a[176:179], v[124:127]
    ds_read_b128 a[96:99], v14 offset:6144
    ds_read_b128 a[100:103], v14 offset:8192
    v_mfma_f32_16x16x32_bf16 v[156:159], a[116:119], a[180:183], v[156:159]
    ds_read_b64_tr_b16 a[32:33], v15 offset:8192
    v_mfma_f32_16x16x32_bf16 v[188:191], a[116:119], a[184:187], v[188:191]
    ds_read_b64_tr_b16 a[34:35], v15 offset:9216
    ds_read_b64_tr_b16 a[36:37], v16 offset:8192
    v_mfma_f32_16x16x32_bf16 v[64:67], a[120:123], a[168:171], v[64:67]
    ds_read_b64_tr_b16 a[38:39], v16 offset:9216
    v_mfma_f32_16x16x32_bf16 v[96:99], a[120:123], a[172:175], v[96:99]
    ds_read_b64_tr_b16 a[40:41], v17 offset:8192
    ds_read_b64_tr_b16 a[42:43], v17 offset:9216
    v_mfma_f32_16x16x32_bf16 v[128:131], a[120:123], a[176:179], v[128:131]
    ds_read_b64_tr_b16 a[44:45], v18 offset:8192
    v_mfma_f32_16x16x32_bf16 v[160:163], a[120:123], a[180:183], v[160:163]
    ds_read_b64_tr_b16 a[46:47], v18 offset:9216
    ds_read_b64_tr_b16 a[48:49], v19 offset:8192
    v_mfma_f32_16x16x32_bf16 v[192:195], a[120:123], a[184:187], v[192:195]
    ds_read_b64_tr_b16 a[50:51], v19 offset:9216
    v_mfma_f32_16x16x32_bf16 v[68:71], a[124:127], a[168:171], v[68:71]
    ds_read_b64_tr_b16 a[52:53], v20 offset:8192
    ds_read_b64_tr_b16 a[54:55], v20 offset:9216
    v_mfma_f32_16x16x32_bf16 v[100:103], a[124:127], a[172:175], v[100:103]
    ds_read_b64_tr_b16 a[56:57], v21 offset:8192
    v_mfma_f32_16x16x32_bf16 v[132:135], a[124:127], a[176:179], v[132:135]
    ds_read_b64_tr_b16 a[58:59], v21 offset:9216
    ds_read_b64_tr_b16 a[60:61], v22 offset:8192
    v_mfma_f32_16x16x32_bf16 v[164:167], a[124:127], a[180:183], v[164:167]
    ds_read_b64_tr_b16 a[62:63], v22 offset:9216
    v_mfma_f32_16x16x32_bf16 v[196:199], a[124:127], a[184:187], v[196:199]
    v_mfma_f32_16x16x32_bf16 v[72:75], a[128:131], a[168:171], v[72:75]
    v_mfma_f32_16x16x32_bf16 v[104:107], a[128:131], a[172:175], v[104:107]
    v_mfma_f32_16x16x32_bf16 v[136:139], a[128:131], a[176:179], v[136:139]
    s_waitcnt lgkmcnt(0)
    s_barrier
    v_mfma_f32_16x16x32_bf16 v[168:171], a[128:131], a[180:183], v[168:171]
    s_add_u32 m0, s66, 32768
    s_add_u32 s51, s56, 0
    buffer_load_dwordx4 v8, s[12:15], s51 offen offset:0 lds
    v_mfma_f32_16x16x32_bf16 v[200:203], a[128:131], a[184:187], v[200:203]
    v_mfma_f32_16x16x32_bf16 v[76:79], a[132:135], a[168:171], v[76:79]
    v_mfma_f32_16x16x32_bf16 v[108:111], a[132:135], a[172:175], v[108:111]
    s_add_u32 s51, s56, 31744
    buffer_load_dwordx4 v8, s[12:15], s51 offen offset:1024 lds
    v_mfma_f32_16x16x32_bf16 v[140:143], a[132:135], a[176:179], v[140:143]
    v_mfma_f32_16x16x32_bf16 v[172:175], a[132:135], a[180:183], v[172:175]
    v_mfma_f32_16x16x32_bf16 v[204:207], a[132:135], a[184:187], v[204:207]
    s_add_u32 s51, s56, 63488
    buffer_load_dwordx4 v9, s[12:15], s51 offen offset:2048 lds
    v_mfma_f32_16x16x32_bf16 v[48:51], a[136:139], a[188:191], v[48:51]
    v_mfma_f32_16x16x32_bf16 v[80:83], a[136:139], a[192:195], v[80:83]
    v_mfma_f32_16x16x32_bf16 v[112:115], a[136:139], a[196:199], v[112:115]
    s_add_u32 s51, s56, 95232
    buffer_load_dwordx4 v9, s[12:15], s51 offen offset:3072 lds
    v_mfma_f32_16x16x32_bf16 v[144:147], a[136:139], a[200:203], v[144:147]
    v_mfma_f32_16x16x32_bf16 v[176:179], a[136:139], a[204:207], v[176:179]
    v_mfma_f32_16x16x32_bf16 v[52:55], a[140:143], a[188:191], v[52:55]
    s_add_u32 m0, s66, 36864
    s_add_u32 s51, s56, 131072
    buffer_load_dwordx4 v8, s[12:15], s51 offen offset:0 lds
    v_mfma_f32_16x16x32_bf16 v[84:87], a[140:143], a[192:195], v[84:87]
    v_mfma_f32_16x16x32_bf16 v[116:119], a[140:143], a[196:199], v[116:119]
    v_mfma_f32_16x16x32_bf16 v[148:151], a[140:143], a[200:203], v[148:151]
    v_mfma_f32_16x16x32_bf16 v[180:183], a[140:143], a[204:207], v[180:183]
    s_add_u32 s51, s56, 162816
    buffer_load_dwordx4 v8, s[12:15], s51 offen offset:1024 lds
    v_mfma_f32_16x16x32_bf16 v[56:59], a[144:147], a[188:191], v[56:59]
    v_mfma_f32_16x16x32_bf16 v[88:91], a[144:147], a[192:195], v[88:91]
    v_mfma_f32_16x16x32_bf16 v[120:123], a[144:147], a[196:199], v[120:123]
    s_add_u32 s51, s56, 194560
    buffer_load_dwordx4 v9, s[12:15], s51 offen offset:2048 lds
    v_mfma_f32_16x16x32_bf16 v[152:155], a[144:147], a[200:203], v[152:155]
    v_mfma_f32_16x16x32_bf16 v[184:187], a[144:147], a[204:207], v[184:187]
    v_mfma_f32_16x16x32_bf16 v[60:63], a[148:151], a[188:191], v[60:63]
    s_add_u32 s51, s56, 226304
    buffer_load_dwordx4 v9, s[12:15], s51 offen offset:3072 lds
    v_mfma_f32_16x16x32_bf16 v[92:95], a[148:151], a[192:195], v[92:95]
    v_mfma_f32_16x16x32_bf16 v[124:127], a[148:151], a[196:199], v[124:127]
    v_mfma_f32_16x16x32_bf16 v[156:159], a[148:151], a[200:203], v[156:159]
    s_add_u32 m0, s65, 65536
    s_add_u32 s51, s55, 0
    buffer_load_dwordx4 v6, s[8:11], s51 offen offset:0 lds
    v_mfma_f32_16x16x32_bf16 v[188:191], a[148:151], a[204:207], v[188:191]
    v_mfma_f32_16x16x32_bf16 v[64:67], a[152:155], a[188:191], v[64:67]
    v_mfma_f32_16x16x32_bf16 v[96:99], a[152:155], a[192:195], v[96:99]
    s_add_u32 s51, s55, 9216
    buffer_load_dwordx4 v7, s[8:11], s51 offen offset:1024 lds
    v_mfma_f32_16x16x32_bf16 v[128:131], a[152:155], a[196:199], v[128:131]
    v_mfma_f32_16x16x32_bf16 v[160:163], a[152:155], a[200:203], v[160:163]
    v_mfma_f32_16x16x32_bf16 v[192:195], a[152:155], a[204:207], v[192:195]
    v_mfma_f32_16x16x32_bf16 v[68:71], a[156:159], a[188:191], v[68:71]
    s_add_u32 s51, s55, 18432
    buffer_load_dwordx4 v6, s[8:11], s51 offen offset:2048 lds
    v_mfma_f32_16x16x32_bf16 v[100:103], a[156:159], a[192:195], v[100:103]
    v_mfma_f32_16x16x32_bf16 v[132:135], a[156:159], a[196:199], v[132:135]
    v_mfma_f32_16x16x32_bf16 v[164:167], a[156:159], a[200:203], v[164:167]
    s_add_u32 s51, s55, 27648
    buffer_load_dwordx4 v7, s[8:11], s51 offen offset:3072 lds
    v_mfma_f32_16x16x32_bf16 v[196:199], a[156:159], a[204:207], v[196:199]
    v_mfma_f32_16x16x32_bf16 v[72:75], a[160:163], a[188:191], v[72:75]
    v_mfma_f32_16x16x32_bf16 v[104:107], a[160:163], a[192:195], v[104:107]
    s_add_u32 m0, s65, 69632
    s_add_u32 s51, s55, 40960
    buffer_load_dwordx4 v6, s[8:11], s51 offen offset:0 lds
    v_mfma_f32_16x16x32_bf16 v[136:139], a[160:163], a[196:199], v[136:139]
    v_mfma_f32_16x16x32_bf16 v[168:171], a[160:163], a[200:203], v[168:171]
    v_mfma_f32_16x16x32_bf16 v[200:203], a[160:163], a[204:207], v[200:203]
    s_add_u32 s81, s81, 1
    s_cmp_eq_u32 s81, 10
    s_cselect_b32 s81, 0, s81
    s_cselect_b32 s51, -9, 1
    s_lshl_b32 s52, s51, 7
    s_add_u32 s55, s55, s52
    s_lshl_b32 s52, s51, 19
    s_add_u32 s56, s56, s52
    v_mfma_f32_16x16x32_bf16 v[76:79], a[164:167], a[188:191], v[76:79]
    v_mfma_f32_16x16x32_bf16 v[108:111], a[164:167], a[192:195], v[108:111]
    v_mfma_f32_16x16x32_bf16 v[140:143], a[164:167], a[196:199], v[140:143]
    v_mfma_f32_16x16x32_bf16 v[172:175], a[164:167], a[200:203], v[172:175]
    v_mfma_f32_16x16x32_bf16 v[204:207], a[164:167], a[204:207], v[204:207]
    s_add_u32 s60, s60, 1
    s_cmp_lt_u32 s60, 2
    s_cbranch_scc1 L_QL
    v_mfma_f32_16x16x32_bf16 v[48:51], a[0:3], a[64:67], v[48:51]
    s_waitcnt vmcnt(13)
    s_barrier
    v_mfma_f32_16x16x32_bf16 v[80:83], a[0:3], a[68:71], v[80:83]
    ds_read_b128 a[168:171], v13 offset:53248
    ds_read_b128 a[172:175], v13 offset:55296
    v_mfma_f32_16x16x32_bf16 v[112:115], a[0:3], a[72:75], v[112:115]
    ds_read_b128 a[176:179], v13 offset:57344
    v_mfma_f32_16x16x32_bf16 v[144:147], a[0:3], a[76:79], v[144:147]
    ds_read_b128 a[180:183], v13 offset:59392
    ds_read_b128 a[184:187], v13 offset:61440
    v_mfma_f32_16x16x32_bf16 v[176:179], a[0:3], a[80:83], v[176:179]
    ds_read_b64_tr_b16 a[104:105], v15 offset:53248
    v_mfma_f32_16x16x32_bf16 v[52:55], a[4:7], a[64:67], v[52:55]
    ds_read_b64_tr_b16 a[106:107], v15 offset:54272
    ds_read_b64_tr_b16 a[108:109], v16 offset:53248
    v_mfma_f32_16x16x32_bf16 v[84:87], a[4:7], a[68:71], v[84:87]
    ds_read_b64_tr_b16 a[110:111], v16 offset:54272
    v_mfma_f32_16x16x32_bf16 v[116:119], a[4:7], a[72:75], v[116:119]
    ds_read_b64_tr_b16 a[112:113], v17 offset:53248
    ds_read_b64_tr_b16 a[114:115], v17 offset:54272
    v_mfma_f32_16x16x32_bf16 v[148:151], a[4:7], a[76:79], v[148:151]
    ds_read_b64_tr_b16 a[116:117], v18 offset:53248
    v_mfma_f32_16x16x32_bf16 v[180:183], a[4:7], a[80:83], v[180:183]
    ds_read_b64_tr_b16 a[118:119], v18 offset:54272
    ds_read_b64_tr_b16 a[120:121], v19 offset:53248
    v_mfma_f32_16x16x32_bf16 v[56:59], a[8:11], a[64:67], v[56:59]
    ds_read_b64_tr_b16 a[122:123], v19 offset:54272
    v_mfma_f32_16x16x32_bf16 v[88:91], a[8:11], a[68:71], v[88:91]
    ds_read_b64_tr_b16 a[124:125], v20 offset:53248
    ds_read_b64_tr_b16 a[126:127], v20 offset:54272
    v_mfma_f32_16x16x32_bf16 v[120:123], a[8:11], a[72:75], v[120:123]
    ds_read_b64_tr_b16 a[128:129], v21 offset:53248
    v_mfma_f32_16x16x32_bf16 v[152:155], a[8:11], a[76:79], v[152:155]
    ds_read_b64_tr_b16 a[130:131], v21 offset:54272
    ds_read_b64_tr_b16 a[132:133], v22 offset:53248
    v_mfma_f32_16x16x32_bf16 v[184:187], a[8:11], a[80:83], v[184:187]
    ds_read_b64_tr_b16 a[134:135], v22 offset:54272
    v_mfma_f32_16x16x32_bf16 v[60:63], a[12:15], a[64:67], v[60:63]
    ds_read_b128 a[188:191], v14 offset:53248
    ds_read_b128 a[192:195], v14 offset:55296
    v_mfma_f32_16x16x32_bf16 v[92:95], a[12:15], a[68:71], v[92:95]
    ds_read_b128 a[196:199], v14 offset:57344
    v_mfma_f32_16x16x32_bf16 v[124:127], a[12:15], a[72:75], v[124:127]
    ds_read_b128 a[200:203], v14 offset:59392
    ds_read_b128 a[204:207], v14 offset:61440
    v_mfma_f32_16x16x32_bf16 v[156:159], a[12:15], a[76:79], v[156:159]
    ds_read_b64_tr_b16 a[136:137], v15 offset:61440
    v_mfma_f32_16x16x32_bf16 v[188:191], a[12:15], a[80:83], v[188:191]
    ds_read_b64_tr_b16 a[138:139], v15 offset:62464
    ds_read_b64_tr_b16 a[140:141], v16 offset:61440
    v_mfma_f32_16x16x32_bf16 v[64:67], a[16:19], a[64:67], v[64:67]
    ds_read_b64_tr_b16 a[142:143], v16 offset:62464
    v_mfma_f32_16x16x32_bf16 v[96:99], a[16:19], a[68:71], v[96:99]
    ds_read_b64_tr_b16 a[144:145], v17 offset:61440
    ds_read_b64_tr_b16 a[146:147], v17 offset:62464
    v_mfma_f32_16x16x32_bf16 v[128:131], a[16:19], a[72:75], v[128:131]
    ds_read_b64_tr_b16 a[148:149], v18 offset:61440
    v_mfma_f32_16x16x32_bf16 v[160:163], a[16:19], a[76:79], v[160:163]
    ds_read_b64_tr_b16 a[150:151], v18 offset:62464
    ds_read_b64_tr_b16 a[152:153], v19 offset:61440
    v_mfma_f32_16x16x32_bf16 v[192:195], a[16:19], a[80:83], v[192:195]
    ds_read_b64_tr_b16 a[154:155], v19 offset:62464
    v_mfma_f32_16x16x32_bf16 v[68:71], a[20:23], a[64:67], v[68:71]
    ds_read_b64_tr_b16 a[156:157], v20 offset:61440
    ds_read_b64_tr_b16 a[158:159], v20 offset:62464
    v_mfma_f32_16x16x32_bf16 v[100:103], a[20:23], a[68:71], v[100:103]
    ds_read_b64_tr_b16 a[160:161], v21 offset:61440
    v_mfma_f32_16x16x32_bf16 v[132:135], a[20:23], a[72:75], v[132:135]
    ds_read_b64_tr_b16 a[162:163], v21 offset:62464
    ds_read_b64_tr_b16 a[164:165], v22 offset:61440
    v_mfma_f32_16x16x32_bf16 v[164:167], a[20:23], a[76:79], v[164:167]
    ds_read_b64_tr_b16 a[166:167], v22 offset:62464
    v_mfma_f32_16x16x32_bf16 v[196:199], a[20:23], a[80:83], v[196:199]
    v_mfma_f32_16x16x32_bf16 v[72:75], a[24:27], a[64:67], v[72:75]
    v_mfma_f32_16x16x32_bf16 v[104:107], a[24:27], a[68:71], v[104:107]
    v_mfma_f32_16x16x32_bf16 v[136:139], a[24:27], a[72:75], v[136:139]
    s_waitcnt lgkmcnt(0)
    s_barrier
    v_mfma_f32_16x16x32_bf16 v[168:171], a[24:27], a[76:79], v[168:171]
    s_add_u32 m0, s66, 86016
    s_add_u32 s51, s56, 0
    buffer_load_dwordx4 v8, s[12:15], s51 offen offset:0 lds
    v_mfma_f32_16x16x32_bf16 v[200:203], a[24:27], a[80:83], v[200:203]
    v_mfma_f32_16x16x32_bf16 v[76:79], a[28:31], a[64:67], v[76:79]
    s_add_u32 s51, s56, 31744
    buffer_load_dwordx4 v8, s[12:15], s51 offen offset:1024 lds
    v_mfma_f32_16x16x32_bf16 v[108:111], a[28:31], a[68:71], v[108:111]
    v_mfma_f32_16x16x32_bf16 v[140:143], a[28:31], a[72:75], v[140:143]
    s_add_u32 s51, s56, 63488
    buffer_load_dwordx4 v9, s[12:15], s51 offen offset:2048 lds
    v_mfma_f32_16x16x32_bf16 v[172:175], a[28:31], a[76:79], v[172:175]
    v_mfma_f32_16x16x32_bf16 v[204:207], a[28:31], a[80:83], v[204:207]
    v_mfma_f32_16x16x32_bf16 v[48:51], a[32:35], a[84:87], v[48:51]
    s_add_u32 s51, s56, 95232
    buffer_load_dwordx4 v9, s[12:15], s51 offen offset:3072 lds
    v_mfma_f32_16x16x32_bf16 v[80:83], a[32:35], a[88:91], v[80:83]
    v_mfma_f32_16x16x32_bf16 v[112:115], a[32:35], a[92:95], v[112:115]
    s_add_u32 m0, s66, 90112
    s_add_u32 s51, s56, 131072
    buffer_load_dwordx4 v8, s[12:15], s51 offen offset:0 lds
    v_mfma_f32_16x16x32_bf16 v[144:147], a[32:35], a[96:99], v[144:147]
    v_mfma_f32_16x16x32_bf16 v[176:179], a[32:35], a[100:103], v[176:179]
    s_add_u32 s51, s56, 162816
    buffer_load_dwordx4 v8, s[12:15], s51 offen offset:1024 lds
    v_mfma_f32_16x16x32_bf16 v[52:55], a[36:39], a[84:87], v[52:55]
    v_mfma_f32_16x16x32_bf16 v[84:87], a[36:39], a[88:91], v[84:87]
    v_mfma_f32_16x16x32_bf16 v[116:119], a[36:39], a[92:95], v[116:119]
    s_add_u32 s51, s56, 194560
    buffer_load_dwordx4 v9, s[12:15], s51 offen offset:2048 lds
    v_mfma_f32_16x16x32_bf16 v[148:151], a[36:39], a[96:99], v[148:151]
    v_mfma_f32_16x16x32_bf16 v[180:183], a[36:39], a[100:103], v[180:183]
    s_add_u32 s51, s56, 226304
    buffer_load_dwordx4 v9, s[12:15], s51 offen offset:3072 lds
    v_mfma_f32_16x16x32_bf16 v[56:59], a[40:43], a[84:87], v[56:59]
    v_mfma_f32_16x16x32_bf16 v[88:91], a[40:43], a[88:91], v[88:91]
    s_add_u32 m0, s65, 118784
    s_add_u32 s51, s55, 0
    buffer_load_dwordx4 v6, s[8:11], s51 offen offset:0 lds
    v_mfma_f32_16x16x32_bf16 v[120:123], a[40:43], a[92:95], v[120:123]
    v_mfma_f32_16x16x32_bf16 v[152:155], a[40:43], a[96:99], v[152:155]
    v_mfma_f32_16x16x32_bf16 v[184:187], a[40:43], a[100:103], v[184:187]
    s_add_u32 s51, s55, 9216
    buffer_load_dwordx4 v7, s[8:11], s51 offen offset:1024 lds
    v_mfma_f32_16x16x32_bf16 v[60:63], a[44:47], a[84:87], v[60:63]
    v_mfma_f32_16x16x32_bf16 v[92:95], a[44:47], a[88:91], v[92:95]
    s_add_u32 s51, s55, 18432
    buffer_load_dwordx4 v6, s[8:11], s51 offen offset:2048 lds
    v_mfma_f32_16x16x32_bf16 v[124:127], a[44:47], a[92:95], v[124:127]
    v_mfma_f32_16x16x32_bf16 v[156:159], a[44:47], a[96:99], v[156:159]
    v_mfma_f32_16x16x32_bf16 v[188:191], a[44:47], a[100:103], v[188:191]
    s_add_u32 s51, s55, 27648
    buffer_load_dwordx4 v7, s[8:11], s51 offen offset:3072 lds
    v_mfma_f32_16x16x32_bf16 v[64:67], a[48:51], a[84:87], v[64:67]
    v_mfma_f32_16x16x32_bf16 v[96:99], a[48:51], a[88:91], v[96:99]
    s_add_u32 m0, s65, 122880
    s_add_u32 s51, s55, 40960
    buffer_load_dwordx4 v6, s[8:11], s51 offen offset:0 lds
    v_mfma_f32_16x16x32_bf16 v[128:131], a[48:51], a[92:95], v[128:131]
    v_mfma_f32_16x16x32_bf16 v[160:163], a[48:51], a[96:99], v[160:163]
    s_add_u32 m0, s59, 147456
    v_mfma_f32_16x16x32_bf16 v[192:195], a[48:51], a[100:103], v[192:195]
    v_mfma_f32_16x16x32_bf16 v[68:71], a[52:55], a[84:87], v[68:71]
    v_mfma_f32_16x16x32_bf16 v[100:103], a[52:55], a[88:91], v[100:103]
    buffer_load_dwordx4 v10, s[20:23], s58 offen offset:0 nt lds
    v_mfma_f32_16x16x32_bf16 v[132:135], a[52:55], a[92:95], v[132:135]
    v_mfma_f32_16x16x32_bf16 v[164:167], a[52:55], a[96:99], v[164:167]
    buffer_load_dwordx4 v11, s[20:23], s58 offen offset:1024 nt lds
    v_mfma_f32_16x16x32_bf16 v[196:199], a[52:55], a[100:103], v[196:199]
    v_mfma_f32_16x16x32_bf16 v[72:75], a[56:59], a[84:87], v[72:75]
    buffer_load_dwordx4 v10, s[20:23], s58 offen offset:2048 nt lds
    v_mfma_f32_16x16x32_bf16 v[104:107], a[56:59], a[88:91], v[104:107]
    v_mfma_f32_16x16x32_bf16 v[136:139], a[56:59], a[92:95], v[136:139]
    v_mfma_f32_16x16x32_bf16 v[168:171], a[56:59], a[96:99], v[168:171]
    buffer_load_dwordx4 v11, s[20:23], s58 offen offset:3072 nt lds
    v_mfma_f32_16x16x32_bf16 v[200:203], a[56:59], a[100:103], v[200:203]
    v_mfma_f32_16x16x32_bf16 v[76:79], a[60:63], a[84:87], v[76:79]
    s_add_u32 s58, s58, 8192
    v_mfma_f32_16x16x32_bf16 v[108:111], a[60:63], a[88:91], v[108:111]
    v_mfma_f32_16x16x32_bf16 v[140:143], a[60:63], a[92:95], v[140:143]
    v_mfma_f32_16x16x32_bf16 v[172:175], a[60:63], a[96:99], v[172:175]
    v_mfma_f32_16x16x32_bf16 v[204:207], a[60:63], a[100:103], v[204:207]
    v_mfma_f32_16x16x32_bf16 v[48:51], a[104:107], a[168:171], v[48:51]
    s_waitcnt vmcnt(17)
    s_barrier
    v_mfma_f32_16x16x32_bf16 v[80:83], a[104:107], a[172:175], v[80:83]
    ds_read_b128 a[64:67], v13 offset:0
    ds_read_b128 a[68:71], v13 offset:2048
    v_mfma_f32_16x16x32_bf16 v[112:115], a[104:107], a[176:179], v[112:115]
    ds_read_b128 a[72:75], v13 offset:4096
    v_mfma_f32_16x16x32_bf16 v[144:147], a[104:107], a[180:183], v[144:147]
    ds_read_b128 a[76:79], v13 offset:6144
    ds_read_b128 a[80:83], v13 offset:8192
    v_mfma_f32_16x16x32_bf16 v[176:179], a[104:107], a[184:187], v[176:179]
    ds_read_b64_tr_b16 a[0:1], v15 offset:0
    v_mfma_f32_16x16x32_bf16 v[52:55], a[108:111], a[168:171], v[52:55]
    ds_read_b64_tr_b16 a[2:3], v15 offset:1024
    ds_read_b64_tr_b16 a[4:5], v16 offset:0
    v_mfma_f32_16x16x32_bf16 v[84:87], a[108:111], a[172:175], v[84:87]
    ds_read_b64_tr_b16 a[6:7], v16 offset:1024
    v_mfma_f32_16x16x32_bf16 v[116:119], a[108:111], a[176:179], v[116:119]
    ds_read_b64_tr_b16 a[8:9], v17 offset:0
    ds_read_b64_tr_b16 a[10:11], v17 offset:1024
    v_mfma_f32_16x16x32_bf16 v[148:151], a[108:111], a[180:183], v[148:151]
    ds_read_b64_tr_b16 a[12:13], v18 offset:0
    v_mfma_f32_16x16x32_bf16 v[180:183], a[108:111], a[184:187], v[180:183]
    ds_read_b64_tr_b16 a[14:15], v18 offset:1024
    ds_read_b64_tr_b16 a[16:17], v19 offset:0
    v_mfma_f32_16x16x32_bf16 v[56:59], a[112:115], a[168:171], v[56:59]
    ds_read_b64_tr_b16 a[18:19], v19 offset:1024
    v_mfma_f32_16x16x32_bf16 v[88:91], a[112:115], a[172:175], v[88:91]
    ds_read_b64_tr_b16 a[20:21], v20 offset:0
    ds_read_b64_tr_b16 a[22:23], v20 offset:1024
    v_mfma_f32_16x16x32_bf16 v[120:123], a[112:115], a[176:179], v[120:123]
    ds_read_b64_tr_b16 a[24:25], v21 offset:0
    v_mfma_f32_16x16x32_bf16 v[152:155], a[112:115], a[180:183], v[152:155]
    ds_read_b64_tr_b16 a[26:27], v21 offset:1024
    ds_read_b64_tr_b16 a[28:29], v22 offset:0
    v_mfma_f32_16x16x32_bf16 v[184:187], a[112:115], a[184:187], v[184:187]
    ds_read_b64_tr_b16 a[30:31], v22 offset:1024
    v_mfma_f32_16x16x32_bf16 v[60:63], a[116:119], a[168:171], v[60:63]
    ds_read_b128 a[84:87], v14 offset:0
    ds_read_b128 a[88:91], v14 offset:2048
    v_mfma_f32_16x16x32_bf16 v[92:95], a[116:119], a[172:175], v[92:95]
    ds_read_b128 a[92:95], v14 offset:4096
    v_mfma_f32_16x16x32_bf16 v[124:127], a[116:119], a[176:179], v[124:127]
    ds_read_b128 a[96:99], v14 offset:6144
    ds_read_b128 a[100:103], v14 offset:8192
    v_mfma_f32_16x16x32_bf16 v[156:159], a[116:119], a[180:183], v[156:159]
    ds_read_b64_tr_b16 a[32:33], v15 offset:8192
    v_mfma_f32_16x16x32_bf16 v[188:191], a[116:119], a[184:187], v[188:191]
    ds_read_b64_tr_b16 a[34:35], v15 offset:9216
    ds_read_b64_tr_b16 a[36:37], v16 offset:8192
    v_mfma_f32_16x16x32_bf16 v[64:67], a[120:123], a[168:171], v[64:67]
    ds_read_b64_tr_b16 a[38:39], v16 offset:9216
    v_mfma_f32_16x16x32_bf16 v[96:99], a[120:123], a[172:175], v[96:99]
    ds_read_b64_tr_b16 a[40:41], v17 offset:8192
    ds_read_b64_tr_b16 a[42:43], v17 offset:9216
    v_mfma_f32_16x16x32_bf16 v[128:131], a[120:123], a[176:179], v[128:131]
    ds_read_b64_tr_b16 a[44:45], v18 offset:8192
    v_mfma_f32_16x16x32_bf16 v[160:163], a[120:123], a[180:183], v[160:163]
    ds_read_b64_tr_b16 a[46:47], v18 offset:9216
    ds_read_b64_tr_b16 a[48:49], v19 offset:8192
    v_mfma_f32_16x16x32_bf16 v[192:195], a[120:123], a[184:187], v[192:195]
    ds_read_b64_tr_b16 a[50:51], v19 offset:9216
    v_mfma_f32_16x16x32_bf16 v[68:71], a[124:127], a[168:171], v[68:71]
    ds_read_b64_tr_b16 a[52:53], v20 offset:8192
    ds_read_b64_tr_b16 a[54:55], v20 offset:9216
    v_mfma_f32_16x16x32_bf16 v[100:103], a[124:127], a[172:175], v[100:103]
    ds_read_b64_tr_b16 a[56:57], v21 offset:8192
    v_mfma_f32_16x16x32_bf16 v[132:135], a[124:127], a[176:179], v[132:135]
    ds_read_b64_tr_b16 a[58:59], v21 offset:9216
    ds_read_b64_tr_b16 a[60:61], v22 offset:8192
    v_mfma_f32_16x16x32_bf16 v[164:167], a[124:127], a[180:183], v[164:167]
    ds_read_b64_tr_b16 a[62:63], v22 offset:9216
    v_mfma_f32_16x16x32_bf16 v[196:199], a[124:127], a[184:187], v[196:199]
    v_mfma_f32_16x16x32_bf16 v[72:75], a[128:131], a[168:171], v[72:75]
    v_mfma_f32_16x16x32_bf16 v[104:107], a[128:131], a[172:175], v[104:107]
    v_mfma_f32_16x16x32_bf16 v[136:139], a[128:131], a[176:179], v[136:139]
    s_waitcnt lgkmcnt(0)
    s_barrier
    v_mfma_f32_16x16x32_bf16 v[168:171], a[128:131], a[180:183], v[168:171]
    s_add_u32 m0, s59, 32768
    v_mfma_f32_16x16x32_bf16 v[200:203], a[128:131], a[184:187], v[200:203]
    v_mfma_f32_16x16x32_bf16 v[76:79], a[132:135], a[168:171], v[76:79]
    buffer_load_dwordx4 v10, s[16:19], s57 offen offset:0 nt lds
    v_mfma_f32_16x16x32_bf16 v[108:111], a[132:135], a[172:175], v[108:111]
    v_mfma_f32_16x16x32_bf16 v[140:143], a[132:135], a[176:179], v[140:143]
    v_mfma_f32_16x16x32_bf16 v[172:175], a[132:135], a[180:183], v[172:175]
    buffer_load_dwordx4 v11, s[16:19], s57 offen offset:1024 nt lds
    v_mfma_f32_16x16x32_bf16 v[204:207], a[132:135], a[184:187], v[204:207]
    v_mfma_f32_16x16x32_bf16 v[48:51], a[136:139], a[188:191], v[48:51]
    buffer_load_dwordx4 v10, s[16:19], s57 offen offset:2048 nt lds
    v_mfma_f32_16x16x32_bf16 v[80:83], a[136:139], a[192:195], v[80:83]
    v_mfma_f32_16x16x32_bf16 v[112:115], a[136:139], a[196:199], v[112:115]
    v_mfma_f32_16x16x32_bf16 v[144:147], a[136:139], a[200:203], v[144:147]
    buffer_load_dwordx4 v11, s[16:19], s57 offen offset:3072 nt lds
    v_mfma_f32_16x16x32_bf16 v[176:179], a[136:139], a[204:207], v[176:179]
    v_mfma_f32_16x16x32_bf16 v[52:55], a[140:143], a[188:191], v[52:55]
    s_add_u32 s57, s57, 8192
    v_mfma_f32_16x16x32_bf16 v[84:87], a[140:143], a[192:195], v[84:87]
    v_mfma_f32_16x16x32_bf16 v[116:119], a[140:143], a[196:199], v[116:119]
    v_mfma_f32_16x16x32_bf16 v[148:151], a[140:143], a[200:203], v[148:151]
    s_add_u32 m0, s59, 49152
    v_mfma_f32_16x16x32_bf16 v[180:183], a[140:143], a[204:207], v[180:183]
    v_mfma_f32_16x16x32_bf16 v[56:59], a[144:147], a[188:191], v[56:59]
    buffer_load_dwordx4 v10, s[16:19], s57 offen offset:0 nt lds
    v_mfma_f32_16x16x32_bf16 v[88:91], a[144:147], a[192:195], v[88:91]
    v_mfma_f32_16x16x32_bf16 v[120:123], a[144:147], a[196:199], v[120:123]
    v_mfma_f32_16x16x32_bf16 v[152:155], a[144:147], a[200:203], v[152:155]
    buffer_load_dwordx4 v11, s[16:19], s57 offen offset:1024 nt lds
    v_mfma_f32_16x16x32_bf16 v[184:187], a[144:147], a[204:207], v[184:187]
    v_mfma_f32_16x16x32_bf16 v[60:63], a[148:151], a[188:191], v[60:63]
    buffer_load_dwordx4 v10, s[16:19], s57 offen offset:2048 nt lds
    v_mfma_f32_16x16x32_bf16 v[92:95], a[148:151], a[192:195], v[92:95]
    v_mfma_f32_16x16x32_bf16 v[124:127], a[148:151], a[196:199], v[124:127]
    v_mfma_f32_16x16x32_bf16 v[156:159], a[148:151], a[200:203], v[156:159]
    buffer_load_dwordx4 v11, s[16:19], s57 offen offset:3072 nt lds
    v_mfma_f32_16x16x32_bf16 v[188:191], a[148:151], a[204:207], v[188:191]
    v_mfma_f32_16x16x32_bf16 v[64:67], a[152:155], a[188:191], v[64:67]
    s_add_u32 s57, s57, 8192
    v_mfma_f32_16x16x32_bf16 v[96:99], a[152:155], a[192:195], v[96:99]
    v_mfma_f32_16x16x32_bf16 v[128:131], a[152:155], a[196:199], v[128:131]
    v_mfma_f32_16x16x32_bf16 v[160:163], a[152:155], a[200:203], v[160:163]
    s_add_u32 m0, s59, 65536
    v_mfma_f32_16x16x32_bf16 v[192:195], a[152:155], a[204:207], v[192:195]
    v_mfma_f32_16x16x32_bf16 v[68:71], a[156:159], a[188:191], v[68:71]
    buffer_load_dwordx4 v10, s[16:19], s57 offen offset:0 nt lds
    v_mfma_f32_16x16x32_bf16 v[100:103], a[156:159], a[192:195], v[100:103]
    v_mfma_f32_16x16x32_bf16 v[132:135], a[156:159], a[196:199], v[132:135]
    v_mfma_f32_16x16x32_bf16 v[164:167], a[156:159], a[200:203], v[164:167]
    buffer_load_dwordx4 v11, s[16:19], s57 offen offset:1024 nt lds
    v_mfma_f32_16x16x32_bf16 v[196:199], a[156:159], a[204:207], v[196:199]
    v_mfma_f32_16x16x32_bf16 v[72:75], a[160:163], a[188:191], v[72:75]
    buffer_load_dwordx4 v10, s[16:19], s57 offen offset:2048 nt lds
    v_mfma_f32_16x16x32_bf16 v[104:107], a[160:163], a[192:195], v[104:107]
    v_mfma_f32_16x16x32_bf16 v[136:139], a[160:163], a[196:199], v[136:139]
    v_mfma_f32_16x16x32_bf16 v[168:171], a[160:163], a[200:203], v[168:171]
    buffer_load_dwordx4 v11, s[16:19], s57 offen offset:3072 nt lds
    v_mfma_f32_16x16x32_bf16 v[200:203], a[160:163], a[204:207], v[200:203]
    v_mfma_f32_16x16x32_bf16 v[76:79], a[164:167], a[188:191], v[76:79]
    s_add_u32 s57, s57, 8192
    v_mfma_f32_16x16x32_bf16 v[108:111], a[164:167], a[192:195], v[108:111]
    v_mfma_f32_16x16x32_bf16 v[140:143], a[164:167], a[196:199], v[140:143]
    v_mfma_f32_16x16x32_bf16 v[172:175], a[164:167], a[200:203], v[172:175]
    v_mfma_f32_16x16x32_bf16 v[204:207], a[164:167], a[204:207], v[204:207]
    v_mfma_f32_16x16x32_bf16 v[48:51], a[0:3], a[64:67], v[48:51]
    s_waitcnt vmcnt(16)
    s_barrier
    v_mfma_f32_16x16x32_bf16 v[80:83], a[0:3], a[68:71], v[80:83]
    ds_read_b128 a[168:171], v13 offset:53248
    ds_read_b128 a[172:175], v13 offset:55296
    v_mfma_f32_16x16x32_bf16 v[112:115], a[0:3], a[72:75], v[112:115]
    ds_read_b128 a[176:179], v13 offset:57344
    v_mfma_f32_16x16x32_bf16 v[144:147], a[0:3], a[76:79], v[144:147]
    ds_read_b128 a[180:183], v13 offset:59392
    ds_read_b128 a[184:187], v13 offset:61440
    v_mfma_f32_16x16x32_bf16 v[176:179], a[0:3], a[80:83], v[176:179]
    ds_read_b64_tr_b16 a[104:105], v15 offset:53248
    v_mfma_f32_16x16x32_bf16 v[52:55], a[4:7], a[64:67], v[52:55]
    ds_read_b64_tr_b16 a[106:107], v15 offset:54272
    ds_read_b64_tr_b16 a[108:109], v16 offset:53248
    v_mfma_f32_16x16x32_bf16 v[84:87], a[4:7], a[68:71], v[84:87]
    ds_read_b64_tr_b16 a[110:111], v16 offset:54272
    v_mfma_f32_16x16x32_bf16 v[116:119], a[4:7], a[72:75], v[116:119]
    ds_read_b64_tr_b16 a[112:113], v17 offset:53248
    ds_read_b64_tr_b16 a[114:115], v17 offset:54272
    v_mfma_f32_16x16x32_bf16 v[148:151], a[4:7], a[76:79], v[148:151]
    ds_read_b64_tr_b16 a[116:117], v18 offset:53248
    v_mfma_f32_16x16x32_bf16 v[180:183], a[4:7], a[80:83], v[180:183]
    ds_read_b64_tr_b16 a[118:119], v18 offset:54272
    ds_read_b64_tr_b16 a[120:121], v19 offset:53248
    v_mfma_f32_16x16x32_bf16 v[56:59], a[8:11], a[64:67], v[56:59]
    ds_read_b64_tr_b16 a[122:123], v19 offset:54272
    v_mfma_f32_16x16x32_bf16 v[88:91], a[8:11], a[68:71], v[88:91]
    ds_read_b64_tr_b16 a[124:125], v20 offset:53248
    ds_read_b64_tr_b16 a[126:127], v20 offset:54272
    v_mfma_f32_16x16x32_bf16 v[120:123], a[8:11], a[72:75], v[120:123]
    ds_read_b64_tr_b16 a[128:129], v21 offset:53248
    v_mfma_f32_16x16x32_bf16 v[152:155], a[8:11], a[76:79], v[152:155]
    ds_read_b64_tr_b16 a[130:131], v21 offset:54272
    ds_read_b64_tr_b16 a[132:133], v22 offset:53248
    v_mfma_f32_16x16x32_bf16 v[184:187], a[8:11], a[80:83], v[184:187]
    ds_read_b64_tr_b16 a[134:135], v22 offset:54272
    v_mfma_f32_16x16x32_bf16 v[60:63], a[12:15], a[64:67], v[60:63]
    ds_read_b128 a[188:191], v14 offset:53248
    ds_read_b128 a[192:195], v14 offset:55296
    v_mfma_f32_16x16x32_bf16 v[92:95], a[12:15], a[68:71], v[92:95]
    ds_read_b128 a[196:199], v14 offset:57344
    v_mfma_f32_16x16x32_bf16 v[124:127], a[12:15], a[72:75], v[124:127]
    ds_read_b128 a[200:203], v14 offset:59392
    ds_read_b128 a[204:207], v14 offset:61440
    v_mfma_f32_16x16x32_bf16 v[156:159], a[12:15], a[76:79], v[156:159]
    ds_read_b64_tr_b16 a[136:137], v15 offset:61440
    v_mfma_f32_16x16x32_bf16 v[188:191], a[12:15], a[80:83], v[188:191]
    ds_read_b64_tr_b16 a[138:139], v15 offset:62464
    ds_read_b64_tr_b16 a[140:141], v16 offset:61440
    v_mfma_f32_16x16x32_bf16 v[64:67], a[16:19], a[64:67], v[64:67]
    ds_read_b64_tr_b16 a[142:143], v16 offset:62464
    v_mfma_f32_16x16x32_bf16 v[96:99], a[16:19], a[68:71], v[96:99]
    ds_read_b64_tr_b16 a[144:145], v17 offset:61440
    ds_read_b64_tr_b16 a[146:147], v17 offset:62464
    v_mfma_f32_16x16x32_bf16 v[128:131], a[16:19], a[72:75], v[128:131]
    ds_read_b64_tr_b16 a[148:149], v18 offset:61440
    v_mfma_f32_16x16x32_bf16 v[160:163], a[16:19], a[76:79], v[160:163]
    ds_read_b64_tr_b16 a[150:151], v18 offset:62464
    ds_read_b64_tr_b16 a[152:153], v19 offset:61440
    v_mfma_f32_16x16x32_bf16 v[192:195], a[16:19], a[80:83], v[192:195]
    ds_read_b64_tr_b16 a[154:155], v19 offset:62464
    v_mfma_f32_16x16x32_bf16 v[68:71], a[20:23], a[64:67], v[68:71]
    ds_read_b64_tr_b16 a[156:157], v20 offset:61440
    ds_read_b64_tr_b16 a[158:159], v20 offset:62464
    v_mfma_f32_16x16x32_bf16 v[100:103], a[20:23], a[68:71], v[100:103]
    ds_read_b64_tr_b16 a[160:161], v21 offset:61440
    v_mfma_f32_16x16x32_bf16 v[132:135], a[20:23], a[72:75], v[132:135]
    ds_read_b64_tr_b16 a[162:163], v21 offset:62464
    ds_read_b64_tr_b16 a[164:165], v22 offset:61440
    v_mfma_f32_16x16x32_bf16 v[164:167], a[20:23], a[76:79], v[164:167]
    ds_read_b64_tr_b16 a[166:167], v22 offset:62464
    v_mfma_f32_16x16x32_bf16 v[196:199], a[20:23], a[80:83], v[196:199]
    v_mfma_f32_16x16x32_bf16 v[72:75], a[24:27], a[64:67], v[72:75]
    v_mfma_f32_16x16x32_bf16 v[104:107], a[24:27], a[68:71], v[104:107]
    v_mfma_f32_16x16x32_bf16 v[136:139], a[24:27], a[72:75], v[136:139]
    s_waitcnt lgkmcnt(0)
    s_barrier
    v_mfma_f32_16x16x32_bf16 v[168:171], a[24:27], a[76:79], v[168:171]
    s_add_u32 m0, s59, 81920
    v_mfma_f32_16x16x32_bf16 v[200:203], a[24:27], a[80:83], v[200:203]
    v_mfma_f32_16x16x32_bf16 v[76:79], a[28:31], a[64:67], v[76:79]
    v_mfma_f32_16x16x32_bf16 v[108:111], a[28:31], a[68:71], v[108:111]
    buffer_load_dwordx4 v10, s[20:23], s58 offen offset:0 nt lds
    v_mfma_f32_16x16x32_bf16 v[140:143], a[28:31], a[72:75], v[140:143]
    v_mfma_f32_16x16x32_bf16 v[172:175], a[28:31], a[76:79], v[172:175]
    v_mfma_f32_16x16x32_bf16 v[204:207], a[28:31], a[80:83], v[204:207]
    v_mfma_f32_16x16x32_bf16 v[48:51], a[32:35], a[84:87], v[48:51]
    buffer_load_dwordx4 v11, s[20:23], s58 offen offset:1024 nt lds
    v_mfma_f32_16x16x32_bf16 v[80:83], a[32:35], a[88:91], v[80:83]
    v_mfma_f32_16x16x32_bf16 v[112:115], a[32:35], a[92:95], v[112:115]
    v_mfma_f32_16x16x32_bf16 v[144:147], a[32:35], a[96:99], v[144:147]
    v_mfma_f32_16x16x32_bf16 v[176:179], a[32:35], a[100:103], v[176:179]
    buffer_load_dwordx4 v10, s[20:23], s58 offen offset:2048 nt lds
    v_mfma_f32_16x16x32_bf16 v[52:55], a[36:39], a[84:87], v[52:55]
    v_mfma_f32_16x16x32_bf16 v[84:87], a[36:39], a[88:91], v[84:87]
    v_mfma_f32_16x16x32_bf16 v[116:119], a[36:39], a[92:95], v[116:119]
    v_mfma_f32_16x16x32_bf16 v[148:151], a[36:39], a[96:99], v[148:151]
    buffer_load_dwordx4 v11, s[20:23], s58 offen offset:3072 nt lds
    v_mfma_f32_16x16x32_bf16 v[180:183], a[36:39], a[100:103], v[180:183]
    v_mfma_f32_16x16x32_bf16 v[56:59], a[40:43], a[84:87], v[56:59]
    v_mfma_f32_16x16x32_bf16 v[88:91], a[40:43], a[88:91], v[88:91]
    s_add_u32 s58, s58, 8192
    v_mfma_f32_16x16x32_bf16 v[120:123], a[40:43], a[92:95], v[120:123]
    v_mfma_f32_16x16x32_bf16 v[152:155], a[40:43], a[96:99], v[152:155]
    v_mfma_f32_16x16x32_bf16 v[184:187], a[40:43], a[100:103], v[184:187]
    v_mfma_f32_16x16x32_bf16 v[60:63], a[44:47], a[84:87], v[60:63]
    s_add_u32 m0, s59, 98304
    v_mfma_f32_16x16x32_bf16 v[92:95], a[44:47], a[88:91], v[92:95]
    v_mfma_f32_16x16x32_bf16 v[124:127], a[44:47], a[92:95], v[124:127]
    v_mfma_f32_16x16x32_bf16 v[156:159], a[44:47], a[96:99], v[156:159]
    v_mfma_f32_16x16x32_bf16 v[188:191], a[44:47], a[100:103], v[188:191]
    buffer_load_dwordx4 v10, s[20:23], s58 offen offset:0 nt lds
    v_mfma_f32_16x16x32_bf16 v[64:67], a[48:51], a[84:87], v[64:67]
    v_mfma_f32_16x16x32_bf16 v[96:99], a[48:51], a[88:91], v[96:99]
    v_mfma_f32_16x16x32_bf16 v[128:131], a[48:51], a[92:95], v[128:131]
    v_mfma_f32_16x16x32_bf16 v[160:163], a[48:51], a[96:99], v[160:163]
    buffer_load_dwordx4 v11, s[20:23], s58 offen offset:1024 nt lds
    v_mfma_f32_16x16x32_bf16 v[192:195], a[48:51], a[100:103], v[192:195]
    v_mfma_f32_16x16x32_bf16 v[68:71], a[52:55], a[84:87], v[68:71]
    v_mfma_f32_16x16x32_bf16 v[100:103], a[52:55], a[88:91], v[100:103]
    buffer_load_dwordx4 v10, s[20:23], s58 offen offset:2048 nt lds
    v_mfma_f32_16x16x32_bf16 v[132:135], a[52:55], a[92:95], v[132:135]
    v_mfma_f32_16x16x32_bf16 v[164:167], a[52:55], a[96:99], v[164:167]
    v_mfma_f32_16x16x32_bf16 v[196:199], a[52:55], a[100:103], v[196:199]
    v_mfma_f32_16x16x32_bf16 v[72:75], a[56:59], a[84:87], v[72:75]
    buffer_load_dwordx4 v11, s[20:23], s58 offen offset:3072 nt lds
    v_mfma_f32_16x16x32_bf16 v[104:107], a[56:59], a[88:91], v[104:107]
    v_mfma_f32_16x16x32_bf16 v[136:139], a[56:59], a[92:95], v[136:139]
    v_mfma_f32_16x16x32_bf16 v[168:171], a[56:59], a[96:99], v[168:171]
    v_mfma_f32_16x16x32_bf16 v[200:203], a[56:59], a[100:103], v[200:203]
    s_add_u32 s58, s58, 8192
    v_mfma_f32_16x16x32_bf16 v[76:79], a[60:63], a[84:87], v[76:79]
    v_mfma_f32_16x16x32_bf16 v[108:111], a[60:63], a[88:91], v[108:111]
    v_mfma_f32_16x16x32_bf16 v[140:143], a[60:63], a[92:95], v[140:143]
    v_mfma_f32_16x16x32_bf16 v[172:175], a[60:63], a[96:99], v[172:175]
    v_mfma_f32_16x16x32_bf16 v[204:207], a[60:63], a[100:103], v[204:207]
    v_mfma_f32_16x16x32_bf16 v[48:51], a[104:107], a[168:171], v[48:51]
    s_add_u32 m0, s59, 114688
    v_mfma_f32_16x16x32_bf16 v[80:83], a[104:107], a[172:175], v[80:83]
    v_mfma_f32_16x16x32_bf16 v[112:115], a[104:107], a[176:179], v[112:115]
    v_mfma_f32_16x16x32_bf16 v[144:147], a[104:107], a[180:183], v[144:147]
    v_mfma_f32_16x16x32_bf16 v[176:179], a[104:107], a[184:187], v[176:179]
    v_mfma_f32_16x16x32_bf16 v[52:55], a[108:111], a[168:171], v[52:55]
    v_mfma_f32_16x16x32_bf16 v[84:87], a[108:111], a[172:175], v[84:87]
    v_mfma_f32_16x16x32_bf16 v[116:119], a[108:111], a[176:179], v[116:119]
    v_mfma_f32_16x16x32_bf16 v[148:151], a[108:111], a[180:183], v[148:151]
    v_mfma_f32_16x16x32_bf16 v[180:183], a[108:111], a[184:187], v[180:183]
    v_mfma_f32_16x16x32_bf16 v[56:59], a[112:115], a[168:171], v[56:59]
    v_mfma_f32_16x16x32_bf16 v[88:91], a[112:115], a[172:175], v[88:91]
    v_mfma_f32_16x16x32_bf16 v[120:123], a[112:115], a[176:179], v[120:123]
    v_mfma_f32_16x16x32_bf16 v[152:155], a[112:115], a[180:183], v[152:155]
    buffer_load_dwordx4 v10, s[20:23], s58 offen offset:0 nt lds
    v_mfma_f32_16x16x32_bf16 v[184:187], a[112:115], a[184:187], v[184:187]
    v_mfma_f32_16x16x32_bf16 v[60:63], a[116:119], a[168:171], v[60:63]
    v_mfma_f32_16x16x32_bf16 v[92:95], a[116:119], a[172:175], v[92:95]
    v_mfma_f32_16x16x32_bf16 v[124:127], a[116:119], a[176:179], v[124:127]
    v_mfma_f32_16x16x32_bf16 v[156:159], a[116:119], a[180:183], v[156:159]
    v_mfma_f32_16x16x32_bf16 v[188:191], a[116:119], a[184:187], v[188:191]
    v_mfma_f32_16x16x32_bf16 v[64:67], a[120:123], a[168:171], v[64:67]
    v_mfma_f32_16x16x32_bf16 v[96:99], a[120:123], a[172:175], v[96:99]
    v_mfma_f32_16x16x32_bf16 v[128:131], a[120:123], a[176:179], v[128:131]
    v_mfma_f32_16x16x32_bf16 v[160:163], a[120:123], a[180:183], v[160:163]
    v_mfma_f32_16x16x32_bf16 v[192:195], a[120:123], a[184:187], v[192:195]
    v_mfma_f32_16x16x32_bf16 v[68:71], a[124:127], a[168:171], v[68:71]
    v_mfma_f32_16x16x32_bf16 v[100:103], a[124:127], a[172:175], v[100:103]
    buffer_load_dwordx4 v11, s[20:23], s58 offen offset:1024 nt lds
    v_mfma_f32_16x16x32_bf16 v[132:135], a[124:127], a[176:179], v[132:135]
    v_mfma_f32_16x16x32_bf16 v[164:167], a[124:127], a[180:183], v[164:167]
    v_mfma_f32_16x16x32_bf16 v[196:199], a[124:127], a[184:187], v[196:199]
    v_mfma_f32_16x16x32_bf16 v[72:75], a[128:131], a[168:171], v[72:75]
    v_mfma_f32_16x16x32_bf16 v[104:107], a[128:131], a[172:175], v[104:107]
    v_mfma_f32_16x16x32_bf16 v[136:139], a[128:131], a[176:179], v[136:139]
    v_mfma_f32_16x16x32_bf16 v[168:171], a[128:131], a[180:183], v[168:171]
    v_mfma_f32_16x16x32_bf16 v[200:203], a[128:131], a[184:187], v[200:203]
    v_mfma_f32_16x16x32_bf16 v[76:79], a[132:135], a[168:171], v[76:79]
    v_mfma_f32_16x16x32_bf16 v[108:111], a[132:135], a[172:175], v[108:111]
    v_mfma_f32_16x16x32_bf16 v[140:143], a[132:135], a[176:179], v[140:143]
    v_mfma_f32_16x16x32_bf16 v[172:175], a[132:135], a[180:183], v[172:175]
    v_mfma_f32_16x16x32_bf16 v[204:207], a[132:135], a[184:187], v[204:207]
    buffer_load_dwordx4 v10, s[20:23], s58 offen offset:2048 nt lds
    v_mfma_f32_16x16x32_bf16 v[48:51], a[136:139], a[188:191], v[48:51]
    v_mfma_f32_16x16x32_bf16 v[80:83], a[136:139], a[192:195], v[80:83]
    v_mfma_f32_16x16x32_bf16 v[112:115], a[136:139], a[196:199], v[112:115]
    v_mfma_f32_16x16x32_bf16 v[144:147], a[136:139], a[200:203], v[144:147]
    v_mfma_f32_16x16x32_bf16 v[176:179], a[136:139], a[204:207], v[176:179]
    v_mfma_f32_16x16x32_bf16 v[52:55], a[140:143], a[188:191], v[52:55]
    v_mfma_f32_16x16x32_bf16 v[84:87], a[140:143], a[192:195], v[84:87]
    v_mfma_f32_16x16x32_bf16 v[116:119], a[140:143], a[196:199], v[116:119]
    v_mfma_f32_16x16x32_bf16 v[148:151], a[140:143], a[200:203], v[148:151]
    v_mfma_f32_16x16x32_bf16 v[180:183], a[140:143], a[204:207], v[180:183]
    v_mfma_f32_16x16x32_bf16 v[56:59], a[144:147], a[188:191], v[56:59]
    v_mfma_f32_16x16x32_bf16 v[88:91], a[144:147], a[192:195], v[88:91]
    v_mfma_f32_16x16x32_bf16 v[120:123], a[144:147], a[196:199], v[120:123]
    buffer_load_dwordx4 v11, s[20:23], s58 offen offset:3072 nt lds
    v_mfma_f32_16x16x32_bf16 v[152:155], a[144:147], a[200:203], v[152:155]
    v_mfma_f32_16x16x32_bf16 v[184:187], a[144:147], a[204:207], v[184:187]
    v_mfma_f32_16x16x32_bf16 v[60:63], a[148:151], a[188:191], v[60:63]
    v_mfma_f32_16x16x32_bf16 v[92:95], a[148:151], a[192:195], v[92:95]
    v_mfma_f32_16x16x32_bf16 v[124:127], a[148:151], a[196:199], v[124:127]
    v_mfma_f32_16x16x32_bf16 v[156:159], a[148:151], a[200:203], v[156:159]
    v_mfma_f32_16x16x32_bf16 v[188:191], a[148:151], a[204:207], v[188:191]
    v_mfma_f32_16x16x32_bf16 v[64:67], a[152:155], a[188:191], v[64:67]
    v_mfma_f32_16x16x32_bf16 v[96:99], a[152:155], a[192:195], v[96:99]
    v_mfma_f32_16x16x32_bf16 v[128:131], a[152:155], a[196:199], v[128:131]
    v_mfma_f32_16x16x32_bf16 v[160:163], a[152:155], a[200:203], v[160:163]
    v_mfma_f32_16x16x32_bf16 v[192:195], a[152:155], a[204:207], v[192:195]
    v_mfma_f32_16x16x32_bf16 v[68:71], a[156:159], a[188:191], v[68:71]
    s_add_u32 s58, s58, 8192
    v_mfma_f32_16x16x32_bf16 v[100:103], a[156:159], a[192:195], v[100:103]
    v_mfma_f32_16x16x32_bf16 v[132:135], a[156:159], a[196:199], v[132:135]
    v_mfma_f32_16x16x32_bf16 v[164:167], a[156:159], a[200:203], v[164:167]
    v_mfma_f32_16x16x32_bf16 v[196:199], a[156:159], a[204:207], v[196:199]
    v_mfma_f32_16x16x32_bf16 v[72:75], a[160:163], a[188:191], v[72:75]
    v_mfma_f32_16x16x32_bf16 v[104:107], a[160:163], a[192:195], v[104:107]
    v_mfma_f32_16x16x32_bf16 v[136:139], a[160:163], a[196:199], v[136:139]
    v_mfma_f32_16x16x32_bf16 v[168:171], a[160:163], a[200:203], v[168:171]
    v_mfma_f32_16x16x32_bf16 v[200:203], a[160:163], a[204:207], v[200:203]
    v_mfma_f32_16x16x32_bf16 v[76:79], a[164:167], a[188:191], v[76:79]
    v_mfma_f32_16x16x32_bf16 v[108:111], a[164:167], a[192:195], v[108:111]
    v_mfma_f32_16x16x32_bf16 v[140:143], a[164:167], a[196:199], v[140:143]
    v_mfma_f32_16x16x32_bf16 v[172:175], a[164:167], a[200:203], v[172:175]
    v_mfma_f32_16x16x32_bf16 v[204:207], a[164:167], a[204:207], v[204:207]
    v_mul_f32 v48, s69, v48
    v_mul_f32 v52, s69, v52
    v_mul_f32 v49, s69, v49
    v_mul_f32 v53, s69, v53
    v_mul_f32 v50, s69, v50
    v_mul_f32 v54, s69, v54
    v_mul_f32 v51, s69, v51
    v_mul_f32 v55, s69, v55
    v_cvt_pk_bf16_f32 v240, v48, v49
    v_cvt_pk_bf16_f32 v242, v52, v53
    v_cvt_pk_bf16_f32 v241, v50, v51
    v_cvt_pk_bf16_f32 v243, v54, v55
    v_permlane32_swap_b32 v240, v242
    s_nop 0
    v_permlane32_swap_b32 v241, v243
    v_permlane16_swap_b32 v240, v242
    s_nop 0
    v_permlane16_swap_b32 v241, v243
    v_accvgpr_write_b32 a160, v240
    v_accvgpr_write_b32 a161, v241
    v_accvgpr_write_b32 a162, v242
    v_accvgpr_write_b32 a163, v243
    v_mul_f32 v56, s69, v56
    v_mul_f32 v60, s69, v60
    v_mul_f32 v57, s69, v57
    v_mul_f32 v61, s69, v61
    v_mul_f32 v58, s69, v58
    v_mul_f32 v62, s69, v62
    v_mul_f32 v59, s69, v59
    v_mul_f32 v63, s69, v63
    v_cvt_pk_bf16_f32 v244, v56, v57
    v_cvt_pk_bf16_f32 v246, v60, v61
    v_cvt_pk_bf16_f32 v245, v58, v59
    v_cvt_pk_bf16_f32 v247, v62, v63
    v_permlane32_swap_b32 v244, v246
    s_nop 0
    v_permlane32_swap_b32 v245, v247
    v_permlane16_swap_b32 v244, v246
    s_nop 0
    v_permlane16_swap_b32 v245, v247
    v_accvgpr_write_b32 a164, v244
    v_accvgpr_write_b32 a165, v245
    v_accvgpr_write_b32 a166, v246
    v_accvgpr_write_b32 a167, v247
    v_mul_f32 v64, s69, v64
    v_mul_f32 v68, s69, v68
    v_mul_f32 v65, s69, v65
    v_mul_f32 v69, s69, v69
    v_mul_f32 v66, s69, v66
    v_mul_f32 v70, s69, v70
    v_mul_f32 v67, s69, v67
    v_mul_f32 v71, s69, v71
    v_cvt_pk_bf16_f32 v240, v64, v65
    v_cvt_pk_bf16_f32 v242, v68, v69
    v_cvt_pk_bf16_f32 v241, v66, v67
    v_cvt_pk_bf16_f32 v243, v70, v71
    v_permlane32_swap_b32 v240, v242
    s_nop 0
    v_permlane32_swap_b32 v241, v243
    v_permlane16_swap_b32 v240, v242
    s_nop 0
    v_permlane16_swap_b32 v241, v243
    v_accvgpr_write_b32 a168, v240
    v_accvgpr_write_b32 a169, v241
    v_accvgpr_write_b32 a170, v242
    v_accvgpr_write_b32 a171, v243
    v_mul_f32 v72, s69, v72
    v_mul_f32 v76, s69, v76
    v_mul_f32 v73, s69, v73
    v_mul_f32 v77, s69, v77
    v_mul_f32 v74, s69, v74
    v_mul_f32 v78, s69, v78
    v_mul_f32 v75, s69, v75
    v_mul_f32 v79, s69, v79
    v_cvt_pk_bf16_f32 v244, v72, v73
    v_cvt_pk_bf16_f32 v246, v76, v77
    v_cvt_pk_bf16_f32 v245, v74, v75
    v_cvt_pk_bf16_f32 v247, v78, v79
    v_permlane32_swap_b32 v244, v246
    s_nop 0
    v_permlane32_swap_b32 v245, v247
    v_permlane16_swap_b32 v244, v246
    s_nop 0
    v_permlane16_swap_b32 v245, v247
    v_accvgpr_write_b32 a172, v244
    v_accvgpr_write_b32 a173, v245
    v_accvgpr_write_b32 a174, v246
    v_accvgpr_write_b32 a175, v247
    v_mul_f32 v80, s69, v80
    v_mul_f32 v84, s69, v84
    v_mul_f32 v81, s69, v81
    v_mul_f32 v85, s69, v85
    v_mul_f32 v82, s69, v82
    v_mul_f32 v86, s69, v86
    v_mul_f32 v83, s69, v83
    v_mul_f32 v87, s69, v87
    v_cvt_pk_bf16_f32 v240, v80, v81
    v_cvt_pk_bf16_f32 v242, v84, v85
    v_cvt_pk_bf16_f32 v241, v82, v83
    v_cvt_pk_bf16_f32 v243, v86, v87
    v_permlane32_swap_b32 v240, v242
    s_nop 0
    v_permlane32_swap_b32 v241, v243
    v_permlane16_swap_b32 v240, v242
    s_nop 0
    v_permlane16_swap_b32 v241, v243
    v_accvgpr_write_b32 a176, v240
    v_accvgpr_write_b32 a177, v241
    v_accvgpr_write_b32 a178, v242
    v_accvgpr_write_b32 a179, v243
    v_mul_f32 v88, s69, v88
    v_mul_f32 v92, s69, v92
    v_mul_f32 v89, s69, v89
    v_mul_f32 v93, s69, v93
    v_mul_f32 v90, s69, v90
    v_mul_f32 v94, s69, v94
    v_mul_f32 v91, s69, v91
    v_mul_f32 v95, s69, v95
    v_cvt_pk_bf16_f32 v244, v88, v89
    v_cvt_pk_bf16_f32 v246, v92, v93
    v_cvt_pk_bf16_f32 v245, v90, v91
    v_cvt_pk_bf16_f32 v247, v94, v95
    v_permlane32_swap_b32 v244, v246
    s_nop 0
    v_permlane32_swap_b32 v245, v247
    v_permlane16_swap_b32 v244, v246
    s_nop 0
    v_permlane16_swap_b32 v245, v247
    v_accvgpr_write_b32 a180, v244
    v_accvgpr_write_b32 a181, v245
    v_accvgpr_write_b32 a182, v246
    v_accvgpr_write_b32 a183, v247
    v_mul_f32 v96, s69, v96
    v_mul_f32 v100, s69, v100
    v_mul_f32 v97, s69, v97
    v_mul_f32 v101, s69, v101
    v_mul_f32 v98, s69, v98
    v_mul_f32 v102, s69, v102
    v_mul_f32 v99, s69, v99
    v_mul_f32 v103, s69, v103
    v_cvt_pk_bf16_f32 v240, v96, v97
    v_cvt_pk_bf16_f32 v242, v100, v101
    v_cvt_pk_bf16_f32 v241, v98, v99
    v_cvt_pk_bf16_f32 v243, v102, v103
    v_permlane32_swap_b32 v240, v242
    s_nop 0
    v_permlane32_swap_b32 v241, v243
    v_permlane16_swap_b32 v240, v242
    s_nop 0
    v_permlane16_swap_b32 v241, v243
    v_accvgpr_write_b32 a184, v240
    v_accvgpr_write_b32 a185, v241
    v_accvgpr_write_b32 a186, v242
    v_accvgpr_write_b32 a187, v243
    v_mul_f32 v104, s69, v104
    v_mul_f32 v108, s69, v108
    v_mul_f32 v105, s69, v105
    v_mul_f32 v109, s69, v109
    v_mul_f32 v106, s69, v106
    v_mul_f32 v110, s69, v110
    v_mul_f32 v107, s69, v107
    v_mul_f32 v111, s69, v111
    v_cvt_pk_bf16_f32 v244, v104, v105
    v_cvt_pk_bf16_f32 v246, v108, v109
    v_cvt_pk_bf16_f32 v245, v106, v107
    v_cvt_pk_bf16_f32 v247, v110, v111
    v_permlane32_swap_b32 v244, v246
    s_nop 0
    v_permlane32_swap_b32 v245, v247
    v_permlane16_swap_b32 v244, v246
    s_nop 0
    v_permlane16_swap_b32 v245, v247
    v_accvgpr_write_b32 a188, v244
    v_accvgpr_write_b32 a189, v245
    v_accvgpr_write_b32 a190, v246
    v_accvgpr_write_b32 a191, v247
    v_mul_f32 v112, s69, v112
    v_mul_f32 v116, s69, v116
    v_mul_f32 v113, s69, v113
    v_mul_f32 v117, s69, v117
    v_mul_f32 v114, s69, v114
    v_mul_f32 v118, s69, v118
    v_mul_f32 v115, s69, v115
    v_mul_f32 v119, s69, v119
    v_cvt_pk_bf16_f32 v240, v112, v113
    v_cvt_pk_bf16_f32 v242, v116, v117
    v_cvt_pk_bf16_f32 v241, v114, v115
    v_cvt_pk_bf16_f32 v243, v118, v119
    v_permlane32_swap_b32 v240, v242
    s_nop 0
    v_permlane32_swap_b32 v241, v243
    v_permlane16_swap_b32 v240, v242
    s_nop 0
    v_permlane16_swap_b32 v241, v243
    v_accvgpr_write_b32 a192, v240
    v_accvgpr_write_b32 a193, v241
    v_accvgpr_write_b32 a194, v242
    v_accvgpr_write_b32 a195, v243
    v_mul_f32 v120, s69, v120
    v_mul_f32 v124, s69, v124
    v_mul_f32 v121, s69, v121
    v_mul_f32 v125, s69, v125
    v_mul_f32 v122, s69, v122
    v_mul_f32 v126, s69, v126
    v_mul_f32 v123, s69, v123
    v_mul_f32 v127, s69, v127
    v_cvt_pk_bf16_f32 v244, v120, v121
    v_cvt_pk_bf16_f32 v246, v124, v125
    v_cvt_pk_bf16_f32 v245, v122, v123
    v_cvt_pk_bf16_f32 v247, v126, v127
    v_permlane32_swap_b32 v244, v246
    s_nop 0
    v_permlane32_swap_b32 v245, v247
    v_permlane16_swap_b32 v244, v246
    s_nop 0
    v_permlane16_swap_b32 v245, v247
    v_accvgpr_write_b32 a196, v244
    v_accvgpr_write_b32 a197, v245
    v_accvgpr_write_b32 a198, v246
    v_accvgpr_write_b32 a199, v247
    v_mul_f32 v128, s69, v128
    v_mul_f32 v132, s69, v132
    v_mul_f32 v129, s69, v129
    v_mul_f32 v133, s69, v133
    v_mul_f32 v130, s69, v130
    v_mul_f32 v134, s69, v134
    v_mul_f32 v131, s69, v131
    v_mul_f32 v135, s69, v135
    v_cvt_pk_bf16_f32 v240, v128, v129
    v_cvt_pk_bf16_f32 v242, v132, v133
    v_cvt_pk_bf16_f32 v241, v130, v131
    v_cvt_pk_bf16_f32 v243, v134, v135
    v_permlane32_swap_b32 v240, v242
    s_nop 0
    v_permlane32_swap_b32 v241, v243
    v_permlane16_swap_b32 v240, v242
    s_nop 0
    v_permlane16_swap_b32 v241, v243
    v_accvgpr_write_b32 a200, v240
    v_accvgpr_write_b32 a201, v241
    v_accvgpr_write_b32 a202, v242
    v_accvgpr_write_b32 a203, v243
    v_mul_f32 v136, s69, v136
    v_mul_f32 v140, s69, v140
    v_mul_f32 v137, s69, v137
    v_mul_f32 v141, s69, v141
    v_mul_f32 v138, s69, v138
    v_mul_f32 v142, s69, v142
    v_mul_f32 v139, s69, v139
    v_mul_f32 v143, s69, v143
    v_cvt_pk_bf16_f32 v244, v136, v137
    v_cvt_pk_bf16_f32 v246, v140, v141
    v_cvt_pk_bf16_f32 v245, v138, v139
    v_cvt_pk_bf16_f32 v247, v142, v143
    v_permlane32_swap_b32 v244, v246
    s_nop 0
    v_permlane32_swap_b32 v245, v247
    v_permlane16_swap_b32 v244, v246
    s_nop 0
    v_permlane16_swap_b32 v245, v247
    v_accvgpr_write_b32 a204, v244
    v_accvgpr_write_b32 a205, v245
    v_accvgpr_write_b32 a206, v246
    v_accvgpr_write_b32 a207, v247
    v_mul_f32 v144, s69, v144
    v_mul_f32 v148, s69, v148
    v_mul_f32 v145, s69, v145
    v_mul_f32 v149, s69, v149
    v_mul_f32 v146, s69, v146
    v_mul_f32 v150, s69, v150
    v_mul_f32 v147, s69, v147
    v_mul_f32 v151, s69, v151
    v_cvt_pk_bf16_f32 v240, v144, v145
    v_cvt_pk_bf16_f32 v242, v148, v149
    v_cvt_pk_bf16_f32 v241, v146, v147
    v_cvt_pk_bf16_f32 v243, v150, v151
    v_permlane32_swap_b32 v240, v242
    s_nop 0
    v_permlane32_swap_b32 v241, v243
    v_permlane16_swap_b32 v240, v242
    s_nop 0
    v_permlane16_swap_b32 v241, v243
    v_accvgpr_write_b32 a208, v240
    v_accvgpr_write_b32 a209, v241
    v_accvgpr_write_b32 a210, v242
    v_accvgpr_write_b32 a211, v243
    v_mul_f32 v152, s69, v152
    v_mul_f32 v156, s69, v156
    v_mul_f32 v153, s69, v153
    v_mul_f32 v157, s69, v157
    v_mul_f32 v154, s69, v154
    v_mul_f32 v158, s69, v158
    v_mul_f32 v155, s69, v155
    v_mul_f32 v159, s69, v159
    v_cvt_pk_bf16_f32 v244, v152, v153
    v_cvt_pk_bf16_f32 v246, v156, v157
    v_cvt_pk_bf16_f32 v245, v154, v155
    v_cvt_pk_bf16_f32 v247, v158, v159
    v_permlane32_swap_b32 v244, v246
    s_nop 0
    v_permlane32_swap_b32 v245, v247
    v_permlane16_swap_b32 v244, v246
    s_nop 0
    v_permlane16_swap_b32 v245, v247
    v_accvgpr_write_b32 a212, v244
    v_accvgpr_write_b32 a213, v245
    v_accvgpr_write_b32 a214, v246
    v_accvgpr_write_b32 a215, v247
    v_mul_f32 v160, s69, v160
    v_mul_f32 v164, s69, v164
    v_mul_f32 v161, s69, v161
    v_mul_f32 v165, s69, v165
    v_mul_f32 v162, s69, v162
    v_mul_f32 v166, s69, v166
    v_mul_f32 v163, s69, v163
    v_mul_f32 v167, s69, v167
    v_cvt_pk_bf16_f32 v240, v160, v161
    v_cvt_pk_bf16_f32 v242, v164, v165
    v_cvt_pk_bf16_f32 v241, v162, v163
    v_cvt_pk_bf16_f32 v243, v166, v167
    v_permlane32_swap_b32 v240, v242
    s_nop 0
    v_permlane32_swap_b32 v241, v243
    v_permlane16_swap_b32 v240, v242
    s_nop 0
    v_permlane16_swap_b32 v241, v243
    v_accvgpr_write_b32 a216, v240
    v_accvgpr_write_b32 a217, v241
    v_accvgpr_write_b32 a218, v242
    v_accvgpr_write_b32 a219, v243
    v_mul_f32 v168, s69, v168
    v_mul_f32 v172, s69, v172
    v_mul_f32 v169, s69, v169
    v_mul_f32 v173, s69, v173
    v_mul_f32 v170, s69, v170
    v_mul_f32 v174, s69, v174
    v_mul_f32 v171, s69, v171
    v_mul_f32 v175, s69, v175
    v_cvt_pk_bf16_f32 v244, v168, v169
    v_cvt_pk_bf16_f32 v246, v172, v173
    v_cvt_pk_bf16_f32 v245, v170, v171
    v_cvt_pk_bf16_f32 v247, v174, v175
    v_permlane32_swap_b32 v244, v246
    s_nop 0
    v_permlane32_swap_b32 v245, v247
    v_permlane16_swap_b32 v244, v246
    s_nop 0
    v_permlane16_swap_b32 v245, v247
    v_accvgpr_write_b32 a220, v244
    v_accvgpr_write_b32 a221, v245
    v_accvgpr_write_b32 a222, v246
    v_accvgpr_write_b32 a223, v247
    v_mul_f32 v176, s69, v176
    v_mul_f32 v180, s69, v180
    v_mul_f32 v177, s69, v177
    v_mul_f32 v181, s69, v181
    v_mul_f32 v178, s69, v178
    v_mul_f32 v182, s69, v182
    v_mul_f32 v179, s69, v179
    v_mul_f32 v183, s69, v183
    v_cvt_pk_bf16_f32 v240, v176, v177
    v_cvt_pk_bf16_f32 v242, v180, v181
    v_cvt_pk_bf16_f32 v241, v178, v179
    v_cvt_pk_bf16_f32 v243, v182, v183
    v_permlane32_swap_b32 v240, v242
    s_nop 0
    v_permlane32_swap_b32 v241, v243
    v_permlane16_swap_b32 v240, v242
    s_nop 0
    v_permlane16_swap_b32 v241, v243
    v_accvgpr_write_b32 a224, v240
    v_accvgpr_write_b32 a225, v241
    v_accvgpr_write_b32 a226, v242
    v_accvgpr_write_b32 a227, v243
    v_mul_f32 v184, s69, v184
    v_mul_f32 v188, s69, v188
    v_mul_f32 v185, s69, v185
    v_mul_f32 v189, s69, v189
    v_mul_f32 v186, s69, v186
    v_mul_f32 v190, s69, v190
    v_mul_f32 v187, s69, v187
    v_mul_f32 v191, s69, v191
    v_cvt_pk_bf16_f32 v244, v184, v185
    v_cvt_pk_bf16_f32 v246, v188, v189
    v_cvt_pk_bf16_f32 v245, v186, v187
    v_cvt_pk_bf16_f32 v247, v190, v191
    v_permlane32_swap_b32 v244, v246
    s_nop 0
    v_permlane32_swap_b32 v245, v247
    v_permlane16_swap_b32 v244, v246
    s_nop 0
    v_permlane16_swap_b32 v245, v247
    v_accvgpr_write_b32 a228, v244
    v_accvgpr_write_b32 a229, v245
    v_accvgpr_write_b32 a230, v246
    v_accvgpr_write_b32 a231, v247
    v_mul_f32 v192, s69, v192
    v_mul_f32 v196, s69, v196
    v_mul_f32 v193, s69, v193
    v_mul_f32 v197, s69, v197
    v_mul_f32 v194, s69, v194
    v_mul_f32 v198, s69, v198
    v_mul_f32 v195, s69, v195
    v_mul_f32 v199, s69, v199
    v_cvt_pk_bf16_f32 v240, v192, v193
    v_cvt_pk_bf16_f32 v242, v196, v197
    v_cvt_pk_bf16_f32 v241, v194, v195
    v_cvt_pk_bf16_f32 v243, v198, v199
    v_permlane32_swap_b32 v240, v242
    s_nop 0
    v_permlane32_swap_b32 v241, v243
    v_permlane16_swap_b32 v240, v242
    s_nop 0
    v_permlane16_swap_b32 v241, v243
    v_accvgpr_write_b32 a232, v240
    v_accvgpr_write_b32 a233, v241
    v_accvgpr_write_b32 a234, v242
    v_accvgpr_write_b32 a235, v243
    v_mul_f32 v200, s69, v200
    v_mul_f32 v204, s69, v204
    v_mul_f32 v201, s69, v201
    v_mul_f32 v205, s69, v205
    v_mul_f32 v202, s69, v202
    v_mul_f32 v206, s69, v206
    v_mul_f32 v203, s69, v203
    v_mul_f32 v207, s69, v207
    v_cvt_pk_bf16_f32 v244, v200, v201
    v_cvt_pk_bf16_f32 v246, v204, v205
    v_cvt_pk_bf16_f32 v245, v202, v203
    v_cvt_pk_bf16_f32 v247, v206, v207
    v_permlane32_swap_b32 v244, v246
    s_nop 0
    v_permlane32_swap_b32 v245, v247
    v_permlane16_swap_b32 v244, v246
    s_nop 0
    v_permlane16_swap_b32 v245, v247
    v_accvgpr_write_b32 a236, v244
    v_accvgpr_write_b32 a237, v245
    v_accvgpr_write_b32 a238, v246
    v_accvgpr_write_b32 a239, v247
    v_mov_b32 v148, 1065369472
    v_mov_b32 v149, 1065369472
    v_mov_b32 v150, 1065369472
    v_mov_b32 v151, 1065369472
    s_waitcnt vmcnt(24)
    s_barrier
    ds_read_b128 v[208:211], v23 offset:0
    ds_read_b128 v[224:227], v23 offset:4096
    ds_read_b128 v[212:215], v24 offset:0
    ds_read_b128 v[228:231], v24 offset:4096
    ds_read_b128 v[216:219], v25 offset:0
    ds_read_b128 v[232:235], v25 offset:4096
    ds_read_b128 v[220:223], v26 offset:0
    ds_read_b128 v[236:239], v26 offset:4096
    v_add_u32 v23, 16384, v23
    v_add_u32 v24, 16384, v24
    v_add_u32 v25, 16384, v25
    v_add_u32 v26, 16384, v26
    s_mov_b32 s85, 16384
    s_mov_b32 s86, 147456
    s_add_u32 s89, s59, 0
    s_add_u32 s90, s59, 131072
    s_mov_b32 s60, 0
    s_mov_b32 s78, 6
    s_waitcnt lgkmcnt(0)
    s_barrier
    v_mfma_f32_16x16x32_bf16 v[48:51], v[208:211], a[160:163], 0
    ds_read_b64_tr_b16 v[160:161], v27 offset:0
    ds_read_b64_tr_b16 v[162:163], v27 offset:4096
    v_mfma_f32_16x16x32_bf16 v[52:55], v[224:227], a[160:163], 0
    ds_read_b64_tr_b16 v[164:165], v28 offset:0
    ds_read_b64_tr_b16 v[166:167], v28 offset:4096
    v_mfma_f32_16x16x32_bf16 v[48:51], v[212:215], a[164:167], v[48:51]
    ds_read_b64_tr_b16 v[168:169], v29 offset:0
    ds_read_b64_tr_b16 v[170:171], v29 offset:4096
    v_mfma_f32_16x16x32_bf16 v[52:55], v[228:231], a[164:167], v[52:55]
    ds_read_b64_tr_b16 v[172:173], v30 offset:0
    ds_read_b64_tr_b16 v[174:175], v30 offset:4096
    v_mfma_f32_16x16x32_bf16 v[48:51], v[216:219], a[168:171], v[48:51]
    ds_read_b64_tr_b16 v[176:177], v31 offset:0
    ds_read_b64_tr_b16 v[178:179], v31 offset:4096
    v_mfma_f32_16x16x32_bf16 v[52:55], v[232:235], a[168:171], v[52:55]
    ds_read_b64_tr_b16 v[180:181], v32 offset:0
    ds_read_b64_tr_b16 v[182:183], v32 offset:4096
    v_mfma_f32_16x16x32_bf16 v[48:51], v[220:223], a[172:175], v[48:51]
    ds_read_b64_tr_b16 v[184:185], v33 offset:0
    ds_read_b64_tr_b16 v[186:187], v33 offset:4096
    v_mfma_f32_16x16x32_bf16 v[52:55], v[236:239], a[172:175], v[52:55]
    ds_read_b64_tr_b16 v[188:189], v34 offset:0
    ds_read_b64_tr_b16 v[190:191], v34 offset:4096
    v_mfma_f32_16x16x32_bf16 v[56:59], v[208:211], a[176:179], 0
    v_mfma_f32_16x16x32_bf16 v[60:63], v[224:227], a[176:179], 0
    v_mfma_f32_16x16x32_bf16 v[56:59], v[212:215], a[180:183], v[56:59]
    v_max3_f32 v46, v48, v49, v50
    s_nop 1
    v_max3_f32 v47, v51, v52, v53
    v_max3_f32 v46, v54, v55, v46
    v_max_f32 v46, v46, v47
    v_mov_b32 v47, v46
    s_nop 1
    v_permlane32_swap_b32 v46, v47
    v_max_f32 v46, v46, v47
    v_mov_b32 v47, v46
    s_nop 1
    v_permlane16_swap_b32 v46, v47
    v_max_f32 v46, v46, v47
    v_sub_f32 v108, 3240099840, v46
    v_mov_b32 v109, v108
    v_mov_b32 v110, v108
    v_mov_b32 v111, v108
    v_add_f32 v48, v48, v108
    v_add_f32 v49, v49, v108
    v_add_f32 v50, v50, v108
    v_add_f32 v51, v51, v108
    v_add_f32 v52, v52, v108
    v_add_f32 v53, v53, v108
    v_add_f32 v54, v54, v108
    v_add_f32 v55, v55, v108
    v_exp_f32 v152, v48
    v_exp_f32 v153, v49
    v_exp_f32 v154, v50
    v_exp_f32 v155, v51
    v_cvt_pk_bf16_f32 v88, v152, v153
    v_cvt_pk_bf16_f32 v89, v154, v155
    v_exp_f32 v156, v52
    v_exp_f32 v157, v53
    v_exp_f32 v158, v54
    v_exp_f32 v159, v55
    v_cvt_pk_bf16_f32 v90, v156, v157
    v_cvt_pk_bf16_f32 v91, v158, v159
    v_mfma_f32_16x16x32_bf16 v[60:63], v[228:231], a[180:183], v[60:63]
    v_mfma_f32_16x16x32_bf16 v[56:59], v[216:219], a[184:187], v[56:59]
    v_mfma_f32_16x16x32_bf16 v[60:63], v[232:235], a[184:187], v[60:63]
    v_mfma_f32_16x16x32_bf16 v[56:59], v[220:223], a[188:191], v[56:59]
    v_mfma_f32_16x16x32_bf16 v[60:63], v[236:239], a[188:191], v[60:63]
    v_mfma_f32_16x16x32_bf16 v[64:67], v[208:211], a[192:195], 0
    v_mfma_f32_16x16x32_bf16 v[68:71], v[224:227], a[192:195], 0
    v_mfma_f32_16x16x32_bf16 v[64:67], v[212:215], a[196:199], v[64:67]
    s_nop 3
    v_max3_f32 v46, v56, v57, v58
    v_max3_f32 v47, v59, v60, v61
    v_max3_f32 v46, v62, v63, v46
    v_max_f32 v46, v46, v47
    v_mov_b32 v47, v46
    s_nop 1
    v_permlane32_swap_b32 v46, v47
    v_max_f32 v46, v46, v47
    v_mov_b32 v47, v46
    s_nop 1
    v_permlane16_swap_b32 v46, v47
    v_max_f32 v46, v46, v47
    v_sub_f32 v112, 3240099840, v46
    v_mov_b32 v113, v112
    v_mov_b32 v114, v112
    v_mov_b32 v115, v112
    v_add_f32 v56, v56, v112
    v_add_f32 v57, v57, v112
    v_add_f32 v58, v58, v112
    v_add_f32 v59, v59, v112
    v_add_f32 v60, v60, v112
    v_add_f32 v61, v61, v112
    v_add_f32 v62, v62, v112
    v_add_f32 v63, v63, v112
    v_exp_f32 v152, v56
    v_exp_f32 v153, v57
    v_exp_f32 v154, v58
    v_exp_f32 v155, v59
    v_cvt_pk_bf16_f32 v92, v152, v153
    v_cvt_pk_bf16_f32 v93, v154, v155
    v_exp_f32 v156, v60
    v_exp_f32 v157, v61
    v_exp_f32 v158, v62
    v_exp_f32 v159, v63
    v_cvt_pk_bf16_f32 v94, v156, v157
    v_cvt_pk_bf16_f32 v95, v158, v159
    v_mfma_f32_16x16x32_bf16 v[68:71], v[228:231], a[196:199], v[68:71]
    v_mfma_f32_16x16x32_bf16 v[64:67], v[216:219], a[200:203], v[64:67]
    v_mfma_f32_16x16x32_bf16 v[68:71], v[232:235], a[200:203], v[68:71]
    v_mfma_f32_16x16x32_bf16 v[64:67], v[220:223], a[204:207], v[64:67]
    v_mfma_f32_16x16x32_bf16 v[68:71], v[236:239], a[204:207], v[68:71]
    v_mfma_f32_16x16x32_bf16 v[72:75], v[208:211], a[208:211], 0
    v_mfma_f32_16x16x32_bf16 v[76:79], v[224:227], a[208:211], 0
    v_mfma_f32_16x16x32_bf16 v[72:75], v[212:215], a[212:215], v[72:75]
    s_nop 3
    v_max3_f32 v46, v64, v65, v66
    v_max3_f32 v47, v67, v68, v69
    v_max3_f32 v46, v70, v71, v46
    v_max_f32 v46, v46, v47
    v_mov_b32 v47, v46
    s_nop 1
    v_permlane32_swap_b32 v46, v47
    v_max_f32 v46, v46, v47
    v_mov_b32 v47, v46
    s_nop 1
    v_permlane16_swap_b32 v46, v47
    v_max_f32 v46, v46, v47
    v_sub_f32 v116, 3240099840, v46
    v_mov_b32 v117, v116
    v_mov_b32 v118, v116
    v_mov_b32 v119, v116
    v_add_f32 v64, v64, v116
    v_add_f32 v65, v65, v116
    v_add_f32 v66, v66, v116
    v_add_f32 v67, v67, v116
    v_add_f32 v68, v68, v116
    v_add_f32 v69, v69, v116
    v_add_f32 v70, v70, v116
    v_add_f32 v71, v71, v116
    v_exp_f32 v152, v64
    v_exp_f32 v153, v65
    v_exp_f32 v154, v66
    v_exp_f32 v155, v67
    v_cvt_pk_bf16_f32 v96, v152, v153
    v_cvt_pk_bf16_f32 v97, v154, v155
    v_exp_f32 v156, v68
    v_exp_f32 v157, v69
    v_exp_f32 v158, v70
    v_exp_f32 v159, v71
    v_cvt_pk_bf16_f32 v98, v156, v157
    v_cvt_pk_bf16_f32 v99, v158, v159
    v_mfma_f32_16x16x32_bf16 v[76:79], v[228:231], a[212:215], v[76:79]
    v_mfma_f32_16x16x32_bf16 v[72:75], v[216:219], a[216:219], v[72:75]
    v_mfma_f32_16x16x32_bf16 v[76:79], v[232:235], a[216:219], v[76:79]
    v_mfma_f32_16x16x32_bf16 v[72:75], v[220:223], a[220:223], v[72:75]
    v_mfma_f32_16x16x32_bf16 v[76:79], v[236:239], a[220:223], v[76:79]
    v_mfma_f32_16x16x32_bf16 v[80:83], v[208:211], a[224:227], 0
    ds_read_b128 v[208:211], v23 offset:0
    v_mfma_f32_16x16x32_bf16 v[84:87], v[224:227], a[224:227], 0
    ds_read_b128 v[224:227], v23 offset:4096
    v_mfma_f32_16x16x32_bf16 v[80:83], v[212:215], a[228:231], v[80:83]
    s_nop 1
    v_max3_f32 v46, v72, v73, v74
    v_max3_f32 v47, v75, v76, v77
    v_max3_f32 v46, v78, v79, v46
    v_max_f32 v46, v46, v47
    v_mov_b32 v47, v46
    s_nop 1
    v_permlane32_swap_b32 v46, v47
    v_max_f32 v46, v46, v47
    v_mov_b32 v47, v46
    s_nop 1
    v_permlane16_swap_b32 v46, v47
    v_max_f32 v46, v46, v47
    v_sub_f32 v120, 3240099840, v46
    v_mov_b32 v121, v120
    v_mov_b32 v122, v120
    v_mov_b32 v123, v120
    v_add_f32 v72, v72, v120
    v_add_f32 v73, v73, v120
    v_mfma_f32_16x16x32_bf16 v[84:87], v[228:231], a[228:231], v[84:87]
    v_add_f32 v74, v74, v120
    v_add_f32 v75, v75, v120
    v_mfma_f32_16x16x32_bf16 v[80:83], v[216:219], a[232:235], v[80:83]
    v_add_f32 v76, v76, v120
    v_add_f32 v77, v77, v120
    v_mfma_f32_16x16x32_bf16 v[84:87], v[232:235], a[232:235], v[84:87]
    v_add_f32 v78, v78, v120
    v_add_f32 v79, v79, v120
    v_mfma_f32_16x16x32_bf16 v[80:83], v[220:223], a[236:239], v[80:83]
    v_exp_f32 v152, v72
    v_mfma_f32_16x16x32_bf16 v[84:87], v[236:239], a[236:239], v[84:87]
    s_waitcnt lgkmcnt(10)
    v_exp_f32 v153, v73
    v_mfma_f32_16x16x32_bf16 a[0:3], v[160:163], v[88:91], 0
    v_exp_f32 v154, v74
    v_mfma_f32_16x16x32_bf16 a[4:7], v[164:167], v[88:91], 0
    v_exp_f32 v155, v75
    v_mfma_f32_16x16x32_bf16 a[8:11], v[168:171], v[88:91], 0
    v_cvt_pk_bf16_f32 v100, v152, v153
    v_cvt_pk_bf16_f32 v101, v154, v155
    v_mfma_f32_16x16x32_bf16 a[12:15], v[172:175], v[88:91], 0
    s_waitcnt lgkmcnt(2)
    v_exp_f32 v156, v76
    v_mfma_f32_16x16x32_bf16 a[16:19], v[176:179], v[88:91], 0
    v_exp_f32 v157, v77
    v_mfma_f32_16x16x32_bf16 a[20:23], v[180:183], v[88:91], 0
    ds_read_b128 v[212:215], v24 offset:0
    v_exp_f32 v158, v78
    v_mfma_f32_16x16x32_bf16 a[24:27], v[184:187], v[88:91], 0
    ds_read_b128 v[228:231], v24 offset:4096
    v_exp_f32 v159, v79
    v_mfma_f32_16x16x32_bf16 a[28:31], v[188:191], v[88:91], 0
    ds_read_b128 v[216:219], v25 offset:0
    v_cvt_pk_bf16_f32 v102, v156, v157
    v_cvt_pk_bf16_f32 v103, v158, v159
    v_mfma_f32_16x16x32_bf16 v[128:131], v[148:151], v[88:91], 0
    ds_read_b128 v[232:235], v25 offset:4096
    s_waitcnt lgkmcnt(2)
    v_max3_f32 v46, v80, v81, v82
    v_max3_f32 v47, v83, v84, v85
    v_mfma_f32_16x16x32_bf16 v[48:51], v[208:211], a[160:163], v[108:111]
    ds_read_b128 v[220:223], v26 offset:0
    v_max3_f32 v46, v86, v87, v46
    v_max_f32 v46, v46, v47
    v_mfma_f32_16x16x32_bf16 v[52:55], v[224:227], a[160:163], v[108:111]
    ds_read_b128 v[236:239], v26 offset:4096
    v_mov_b32 v47, v46
    v_mfma_f32_16x16x32_bf16 v[48:51], v[212:215], a[164:167], v[48:51]
    s_nop 0
    v_permlane32_swap_b32 v46, v47
    v_mfma_f32_16x16x32_bf16 v[52:55], v[228:231], a[164:167], v[52:55]
    s_waitcnt lgkmcnt(0)
    v_max_f32 v46, v46, v47
    v_mov_b32 v47, v46
    v_mfma_f32_16x16x32_bf16 v[48:51], v[216:219], a[168:171], v[48:51]
    s_cmp_lt_u32 s60, 11
    s_cselect_b32 s73, s57, 2130706432
    s_cselect_b32 m0, s89, 196608
    v_permlane16_swap_b32 v46, v47
    v_mfma_f32_16x16x32_bf16 v[52:55], v[232:235], a[168:171], v[52:55]
    v_max_f32 v46, v46, v47
    v_sub_f32 v124, 3240099840, v46
    v_mfma_f32_16x16x32_bf16 v[48:51], v[220:223], a[172:175], v[48:51]
    v_mov_b32 v125, v124
    v_mov_b32 v126, v124
    v_mfma_f32_16x16x32_bf16 v[52:55], v[236:239], a[172:175], v[52:55]
    v_mov_b32 v127, v124
    v_add_f32 v80, v80, v124
    v_mfma_f32_16x16x32_bf16 a[32:35], v[160:163], v[92:95], 0
    v_add_f32 v81, v81, v124
    v_add_f32 v82, v82, v124
    v_mfma_f32_16x16x32_bf16 a[36:39], v[164:167], v[92:95], 0
    v_add_f32 v83, v83, v124
    v_add_f32 v84, v84, v124
    v_mfma_f32_16x16x32_bf16 a[40:43], v[168:171], v[92:95], 0
    buffer_load_dwordx4 v10, s[16:19], s73 offen offset:0 nt lds
    v_add_f32 v85, v85, v124
    v_add_f32 v86, v86, v124
    v_mfma_f32_16x16x32_bf16 a[44:47], v[172:175], v[92:95], 0
    buffer_load_dwordx4 v11, s[16:19], s73 offen offset:1024 nt lds
    v_add_f32 v87, v87, v124
    v_mfma_f32_16x16x32_bf16 a[48:51], v[176:179], v[92:95], 0
    v_exp_f32 v152, v80
    v_mfma_f32_16x16x32_bf16 a[52:55], v[180:183], v[92:95], 0
    v_exp_f32 v153, v81
    v_mfma_f32_16x16x32_bf16 a[56:59], v[184:187], v[92:95], 0
    v_exp_f32 v154, v82
    v_mfma_f32_16x16x32_bf16 a[60:63], v[188:191], v[92:95], 0
    v_exp_f32 v155, v83
    v_cvt_pk_bf16_f32 v104, v152, v153
    v_mfma_f32_16x16x32_bf16 v[132:135], v[148:151], v[92:95], 0
    buffer_load_dwordx4 v10, s[16:19], s73 offen offset:2048 nt lds
    v_cvt_pk_bf16_f32 v105, v154, v155
    v_mfma_f32_16x16x32_bf16 v[56:59], v[208:211], a[176:179], v[112:115]
    v_exp_f32 v156, v84
    v_mfma_f32_16x16x32_bf16 v[60:63], v[224:227], a[176:179], v[112:115]
    v_exp_f32 v157, v85
    v_mfma_f32_16x16x32_bf16 v[56:59], v[212:215], a[180:183], v[56:59]
    v_exp_f32 v158, v86
    v_mfma_f32_16x16x32_bf16 v[60:63], v[228:231], a[180:183], v[60:63]
    v_exp_f32 v159, v87
    v_cvt_pk_bf16_f32 v106, v156, v157
    v_mfma_f32_16x16x32_bf16 v[56:59], v[216:219], a[184:187], v[56:59]
    buffer_load_dwordx4 v11, s[16:19], s73 offen offset:3072 nt lds
    v_cvt_pk_bf16_f32 v107, v158, v159
    v_mfma_f32_16x16x32_bf16 v[60:63], v[232:235], a[184:187], v[60:63]
    v_exp_f32 v152, v48
    v_mfma_f32_16x16x32_bf16 v[56:59], v[220:223], a[188:191], v[56:59]
    v_exp_f32 v153, v49
    v_mfma_f32_16x16x32_bf16 v[60:63], v[236:239], a[188:191], v[60:63]
    v_exp_f32 v154, v50
    v_mfma_f32_16x16x32_bf16 a[64:67], v[160:163], v[96:99], 0
    v_exp_f32 v155, v51
    v_cvt_pk_bf16_f32 v88, v152, v153
    v_mfma_f32_16x16x32_bf16 a[68:71], v[164:167], v[96:99], 0
    v_cvt_pk_bf16_f32 v89, v154, v155
    v_mfma_f32_16x16x32_bf16 a[72:75], v[168:171], v[96:99], 0
    v_exp_f32 v156, v52
    v_mfma_f32_16x16x32_bf16 a[76:79], v[172:175], v[96:99], 0
    v_exp_f32 v157, v53
    v_mfma_f32_16x16x32_bf16 a[80:83], v[176:179], v[96:99], 0
    v_exp_f32 v158, v54
    v_mfma_f32_16x16x32_bf16 a[84:87], v[180:183], v[96:99], 0
    v_exp_f32 v159, v55
    v_cvt_pk_bf16_f32 v90, v156, v157
    v_mfma_f32_16x16x32_bf16 a[88:91], v[184:187], v[96:99], 0
    v_cvt_pk_bf16_f32 v91, v158, v159
    v_or3_b32 v43, v88, v89, v90
    v_mfma_f32_16x16x32_bf16 a[92:95], v[188:191], v[96:99], 0
    v_or_b32 v43, v43, v91
    v_and_b32 v45, 1073758208, v43
    v_mfma_f32_16x16x32_bf16 v[136:139], v[148:151], v[96:99], 0
    v_cmp_ne_u32 vcc, 0, v45
    v_mfma_f32_16x16x32_bf16 v[64:67], v[208:211], a[192:195], v[116:119]
    s_cmp_lt_u32 s60, 12
    s_cselect_b32 s74, s58, 2130706432
    s_cselect_b32 m0, s90, 196608
    v_mfma_f32_16x16x32_bf16 v[68:71], v[224:227], a[192:195], v[116:119]
    buffer_load_dwordx4 v10, s[20:23], s74 offen offset:0 nt lds
    buffer_load_dwordx4 v11, s[20:23], s74 offen offset:1024 nt lds
    v_mfma_f32_16x16x32_bf16 v[64:67], v[212:215], a[196:199], v[64:67]
    s_cbranch_vccnz L_STUB0
L_RET0:
    v_mfma_f32_16x16x32_bf16 v[68:71], v[228:231], a[196:199], v[68:71]
    v_exp_f32 v152, v56
    v_mfma_f32_16x16x32_bf16 v[64:67], v[216:219], a[200:203], v[64:67]
    v_exp_f32 v153, v57
    v_mfma_f32_16x16x32_bf16 v[68:71], v[232:235], a[200:203], v[68:71]
    v_exp_f32 v154, v58
    v_mfma_f32_16x16x32_bf16 v[64:67], v[220:223], a[204:207], v[64:67]
    v_exp_f32 v155, v59
    v_mfma_f32_16x16x32_bf16 v[68:71], v[236:239], a[204:207], v[68:71]
    buffer_load_dwordx4 v10, s[20:23], s74 offen offset:2048 nt lds
    v_cvt_pk_bf16_f32 v92, v152, v153
    v_cvt_pk_bf16_f32 v93, v154, v155
    v_mfma_f32_16x16x32_bf16 a[96:99], v[160:163], v[100:103], 0
    v_exp_f32 v156, v60
    v_mfma_f32_16x16x32_bf16 a[100:103], v[164:167], v[100:103], 0
    v_exp_f32 v157, v61
    v_mfma_f32_16x16x32_bf16 a[104:107], v[168:171], v[100:103], 0
    v_exp_f32 v158, v62
    v_mfma_f32_16x16x32_bf16 a[108:111], v[172:175], v[100:103], 0
    buffer_load_dwordx4 v11, s[20:23], s74 offen offset:3072 nt lds
    s_add_u32 s89, s85, s59
    s_add_u32 s87, s85, 16384
    s_add_u32 s90, s86, s59
    s_cmp_eq_u32 s87, 81920
    s_cselect_b32 s51, 0, s87
    s_sub_u32 s87, s51, s85
    s_mov_b32 s85, s51
    s_add_u32 s88, s86, 16384
    s_add_u32 s57, s57, 8192
    s_cmp_eq_u32 s88, 163840
    s_cselect_b32 s51, 81920, s88
    s_sub_u32 s88, s51, s86
    v_exp_f32 v159, v63
    v_mfma_f32_16x16x32_bf16 a[112:115], v[176:179], v[100:103], 0
    s_mov_b32 s86, s51
    s_add_u32 s58, s58, 8192
    s_add_u32 s60, s60, 1
    v_cvt_pk_bf16_f32 v94, v156, v157
    v_cvt_pk_bf16_f32 v95, v158, v159
    v_mfma_f32_16x16x32_bf16 a[116:119], v[180:183], v[100:103], 0
    v_or3_b32 v44, v92, v93, v94
    v_or_b32 v44, v44, v95
    v_mfma_f32_16x16x32_bf16 a[120:123], v[184:187], v[100:103], 0
    v_exp_f32 v152, v64
    v_mfma_f32_16x16x32_bf16 a[124:127], v[188:191], v[100:103], 0
    v_exp_f32 v153, v65
    v_mfma_f32_16x16x32_bf16 v[140:143], v[148:151], v[100:103], 0
    v_add_u32 v23, s87, v23
    v_exp_f32 v154, v66
    v_add_u32 v24, s87, v24
    v_mfma_f32_16x16x32_bf16 v[72:75], v[208:211], a[208:211], v[120:123]
    v_add_u32 v25, s87, v25
    v_exp_f32 v155, v67
    v_add_u32 v26, s87, v26
    v_mfma_f32_16x16x32_bf16 v[76:79], v[224:227], a[208:211], v[120:123]
    v_cvt_pk_bf16_f32 v96, v152, v153
    v_add_u32 v27, s88, v27
    v_cvt_pk_bf16_f32 v97, v154, v155
    v_add_u32 v28, s88, v28
    v_mfma_f32_16x16x32_bf16 v[72:75], v[212:215], a[212:215], v[72:75]
    v_add_u32 v29, s88, v29
    v_exp_f32 v156, v68
    v_add_u32 v30, s88, v30
    v_mfma_f32_16x16x32_bf16 v[76:79], v[228:231], a[212:215], v[76:79]
    v_add_u32 v31, s88, v31
    v_exp_f32 v157, v69
    v_add_u32 v32, s88, v32
    v_mfma_f32_16x16x32_bf16 v[72:75], v[216:219], a[216:219], v[72:75]
    v_add_u32 v33, s88, v33
    v_exp_f32 v158, v70
    v_add_u32 v34, s88, v34
    v_mfma_f32_16x16x32_bf16 v[76:79], v[232:235], a[216:219], v[76:79]
    v_exp_f32 v159, v71
    v_mfma_f32_16x16x32_bf16 v[72:75], v[220:223], a[220:223], v[72:75]
    s_waitcnt vmcnt(16) lgkmcnt(0)
    s_barrier
    v_cvt_pk_bf16_f32 v98, v156, v157
    v_cvt_pk_bf16_f32 v99, v158, v159
    v_mfma_f32_16x16x32_bf16 v[76:79], v[236:239], a[220:223], v[76:79]
    v_or3_b32 v44, v44, v96, v97
    v_or3_b32 v44, v44, v98, v99
    s_cmp_lg_u32 s48, 3
    s_cbranch_scc1 L_NORST
    v_mov_b32 v250, 0
    s_lshl_b32 s51, s83, 5
    s_lshl_b32 s52, s71, 2
    s_add_u32 s51, s51, s52
    s_add_u32 s51, s51, 134217728
    s_lshl_b32 s52, s63, 5
    s_lshl_b32 s53, s70, 2
    s_add_u32 s52, s52, s53
    s_add_u32 s52, s52, 134225920
    s_mov_b64 exec, 1
    buffer_store_dword v250, v12, s[32:35], s51 offen sc1
    s_mov_b64 exec, 15
    buffer_store_dword v250, v12, s[32:35], s52 offen sc1
    s_mov_b64 exec, -1
L_NORST:
    v_mfma_f32_16x16x32_bf16 a[128:131], v[160:163], v[104:107], 0
    v_and_b32 v45, 1073758208, v44
    v_cmp_ne_u32 vcc, 0, v45
    v_mfma_f32_16x16x32_bf16 a[132:135], v[164:167], v[104:107], 0
    ds_read_b64_tr_b16 v[160:161], v27 offset:0
    ds_read_b64_tr_b16 v[162:163], v27 offset:4096
    v_mfma_f32_16x16x32_bf16 a[136:139], v[168:171], v[104:107], 0
    ds_read_b64_tr_b16 v[164:165], v28 offset:0
    ds_read_b64_tr_b16 v[166:167], v28 offset:4096
    v_mfma_f32_16x16x32_bf16 a[140:143], v[172:175], v[104:107], 0
    s_cbranch_vccnz L_STUB1
L_RET1:
    ds_read_b64_tr_b16 v[168:169], v29 offset:0
    v_mfma_f32_16x16x32_bf16 a[144:147], v[176:179], v[104:107], 0
    ds_read_b64_tr_b16 v[170:171], v29 offset:4096
    ds_read_b64_tr_b16 v[172:173], v30 offset:0
    v_mfma_f32_16x16x32_bf16 a[148:151], v[180:183], v[104:107], 0
    ds_read_b64_tr_b16 v[174:175], v30 offset:4096
    ds_read_b64_tr_b16 v[176:177], v31 offset:0
    v_mfma_f32_16x16x32_bf16 a[152:155], v[184:187], v[104:107], 0
    ds_read_b64_tr_b16 v[178:179], v31 offset:4096
    ds_read_b64_tr_b16 v[180:181], v32 offset:0
    v_mfma_f32_16x16x32_bf16 a[156:159], v[188:191], v[104:107], 0
    ds_read_b64_tr_b16 v[182:183], v32 offset:4096
    ds_read_b64_tr_b16 v[184:185], v33 offset:0
    v_mfma_f32_16x16x32_bf16 v[144:147], v[148:151], v[104:107], 0
    ds_read_b64_tr_b16 v[186:187], v33 offset:4096
    ds_read_b64_tr_b16 v[188:189], v34 offset:0
    v_mfma_f32_16x16x32_bf16 v[80:83], v[208:211], a[224:227], v[124:127]
    ds_read_b64_tr_b16 v[190:191], v34 offset:4096
    ds_read_b128 v[208:211], v23 offset:0
    v_mfma_f32_16x16x32_bf16 v[84:87], v[224:227], a[224:227], v[124:127]
    s_cmp_lt_u32 s60, 11
    s_cselect_b32 s73, s57, 2130706432
    s_cselect_b32 m0, s89, 196608
    v_mfma_f32_16x16x32_bf16 v[80:83], v[212:215], a[228:231], v[80:83]
    ds_read_b128 v[224:227], v23 offset:4096
    ds_read_b128 v[212:215], v24 offset:0
    v_mfma_f32_16x16x32_bf16 v[84:87], v[228:231], a[228:231], v[84:87]
    v_exp_f32 v152, v72
    v_mfma_f32_16x16x32_bf16 v[80:83], v[216:219], a[232:235], v[80:83]
    ds_read_b128 v[228:231], v24 offset:4096
    ds_read_b128 v[216:219], v25 offset:0
    v_mfma_f32_16x16x32_bf16 v[84:87], v[232:235], a[232:235], v[84:87]
    ds_read_b128 v[232:235], v25 offset:4096
    buffer_load_dwordx4 v10, s[16:19], s73 offen offset:0 nt lds
    v_mfma_f32_16x16x32_bf16 v[80:83], v[220:223], a[236:239], v[80:83]
    v_exp_f32 v153, v73
    v_mfma_f32_16x16x32_bf16 v[84:87], v[236:239], a[236:239], v[84:87]
    s_waitcnt lgkmcnt(14)
    ds_read_b128 v[220:223], v26 offset:0
    v_mfma_f32_16x16x32_bf16 a[0:3], v[160:163], v[88:91], a[0:3]
    v_exp_f32 v154, v74
    v_mfma_f32_16x16x32_bf16 a[4:7], v[164:167], v[88:91], a[4:7]
    v_exp_f32 v155, v75
    v_mfma_f32_16x16x32_bf16 a[8:11], v[168:171], v[88:91], a[8:11]
    ds_read_b128 v[236:239], v26 offset:4096
    v_cvt_pk_bf16_f32 v100, v152, v153
    v_mfma_f32_16x16x32_bf16 a[12:15], v[172:175], v[88:91], a[12:15]
    s_waitcnt lgkmcnt(8)
    v_cvt_pk_bf16_f32 v101, v154, v155
    v_mfma_f32_16x16x32_bf16 a[16:19], v[176:179], v[88:91], a[16:19]
    v_exp_f32 v156, v76
    v_mfma_f32_16x16x32_bf16 a[20:23], v[180:183], v[88:91], a[20:23]
    v_exp_f32 v157, v77
    v_mfma_f32_16x16x32_bf16 a[24:27], v[184:187], v[88:91], a[24:27]
    v_exp_f32 v158, v78
    v_mfma_f32_16x16x32_bf16 a[28:31], v[188:191], v[88:91], a[28:31]
    v_exp_f32 v159, v79
    v_mfma_f32_16x16x32_bf16 v[128:131], v[148:151], v[88:91], v[128:131]
    s_waitcnt lgkmcnt(4)
    buffer_load_dwordx4 v11, s[16:19], s73 offen offset:1024 nt lds
    v_mfma_f32_16x16x32_bf16 v[48:51], v[208:211], a[160:163], v[108:111]
    v_cvt_pk_bf16_f32 v102, v156, v157
    v_cvt_pk_bf16_f32 v103, v158, v159
    v_mfma_f32_16x16x32_bf16 v[52:55], v[224:227], a[160:163], v[108:111]
    v_or3_b32 v43, v100, v101, v102
    v_or_b32 v43, v43, v103
    v_mfma_f32_16x16x32_bf16 v[48:51], v[212:215], a[164:167], v[48:51]
    v_exp_f32 v152, v80
    v_mfma_f32_16x16x32_bf16 v[52:55], v[228:231], a[164:167], v[52:55]
    s_waitcnt lgkmcnt(0)
    buffer_load_dwordx4 v10, s[16:19], s73 offen offset:2048 nt lds
    v_mfma_f32_16x16x32_bf16 v[48:51], v[216:219], a[168:171], v[48:51]
    v_exp_f32 v153, v81
    v_mfma_f32_16x16x32_bf16 v[52:55], v[232:235], a[168:171], v[52:55]
    v_exp_f32 v154, v82
    v_mfma_f32_16x16x32_bf16 v[48:51], v[220:223], a[172:175], v[48:51]
    v_exp_f32 v155, v83
    v_mfma_f32_16x16x32_bf16 v[52:55], v[236:239], a[172:175], v[52:55]
    v_cvt_pk_bf16_f32 v104, v152, v153
    v_cvt_pk_bf16_f32 v105, v154, v155
    v_mfma_f32_16x16x32_bf16 a[32:35], v[160:163], v[92:95], a[32:35]
    v_exp_f32 v156, v84
    v_mfma_f32_16x16x32_bf16 a[36:39], v[164:167], v[92:95], a[36:39]
    v_exp_f32 v157, v85
    v_mfma_f32_16x16x32_bf16 a[40:43], v[168:171], v[92:95], a[40:43]
    v_exp_f32 v158, v86
    v_mfma_f32_16x16x32_bf16 a[44:47], v[172:175], v[92:95], a[44:47]
    v_exp_f32 v159, v87
    v_mfma_f32_16x16x32_bf16 a[48:51], v[176:179], v[92:95], a[48:51]
    buffer_load_dwordx4 v11, s[16:19], s73 offen offset:3072 nt lds
    v_cvt_pk_bf16_f32 v106, v156, v157
    v_mfma_f32_16x16x32_bf16 a[52:55], v[180:183], v[92:95], a[52:55]
    v_cvt_pk_bf16_f32 v107, v158, v159
    v_or3_b32 v43, v43, v104, v105
    v_mfma_f32_16x16x32_bf16 a[56:59], v[184:187], v[92:95], a[56:59]
    s_cmp_lt_u32 s60, 12
    s_cselect_b32 s74, s58, 2130706432
    s_cselect_b32 m0, s90, 196608
    v_mfma_f32_16x16x32_bf16 a[60:63], v[188:191], v[92:95], a[60:63]
    v_or3_b32 v43, v43, v106, v107
    v_mfma_f32_16x16x32_bf16 v[132:135], v[148:151], v[92:95], v[132:135]
    v_exp_f32 v152, v48
    v_mfma_f32_16x16x32_bf16 v[56:59], v[208:211], a[176:179], v[112:115]
    v_exp_f32 v153, v49
    v_mfma_f32_16x16x32_bf16 v[60:63], v[224:227], a[176:179], v[112:115]
    v_exp_f32 v154, v50
    v_mfma_f32_16x16x32_bf16 v[56:59], v[212:215], a[180:183], v[56:59]
    v_exp_f32 v155, v51
    v_mfma_f32_16x16x32_bf16 v[60:63], v[228:231], a[180:183], v[60:63]
    v_cvt_pk_bf16_f32 v88, v152, v153
    v_cvt_pk_bf16_f32 v89, v154, v155
    v_mfma_f32_16x16x32_bf16 v[56:59], v[216:219], a[184:187], v[56:59]
    v_exp_f32 v156, v52
    v_mfma_f32_16x16x32_bf16 v[60:63], v[232:235], a[184:187], v[60:63]
    v_exp_f32 v157, v53
    v_mfma_f32_16x16x32_bf16 v[56:59], v[220:223], a[188:191], v[56:59]
    v_exp_f32 v158, v54
    v_mfma_f32_16x16x32_bf16 v[60:63], v[236:239], a[188:191], v[60:63]
    v_exp_f32 v159, v55
    v_mfma_f32_16x16x32_bf16 a[64:67], v[160:163], v[96:99], a[64:67]
    v_cvt_pk_bf16_f32 v90, v156, v157
    v_cvt_pk_bf16_f32 v91, v158, v159
    v_mfma_f32_16x16x32_bf16 a[68:71], v[164:167], v[96:99], a[68:71]
    buffer_load_dwordx4 v10, s[20:23], s74 offen offset:0 nt lds
    v_or3_b32 v43, v43, v88, v89
    v_mfma_f32_16x16x32_bf16 a[72:75], v[168:171], v[96:99], a[72:75]
    v_or3_b32 v43, v43, v90, v91
    v_and_b32 v45, 1073758208, v43
    v_mfma_f32_16x16x32_bf16 a[76:79], v[172:175], v[96:99], a[76:79]
    buffer_load_dwordx4 v11, s[20:23], s74 offen offset:1024 nt lds
    v_cmp_ne_u32 vcc, 0, v45
    v_mfma_f32_16x16x32_bf16 a[80:83], v[176:179], v[96:99], a[80:83]
    v_mfma_f32_16x16x32_bf16 a[84:87], v[180:183], v[96:99], a[84:87]
    buffer_load_dwordx4 v10, s[20:23], s74 offen offset:2048 nt lds
    v_mfma_f32_16x16x32_bf16 a[88:91], v[184:187], v[96:99], a[88:91]
    s_cbranch_vccnz L_STUB2
L_RET2:
    v_mfma_f32_16x16x32_bf16 a[92:95], v[188:191], v[96:99], a[92:95]
    v_exp_f32 v152, v56
    v_mfma_f32_16x16x32_bf16 v[136:139], v[148:151], v[96:99], v[136:139]
    v_exp_f32 v153, v57
    v_mfma_f32_16x16x32_bf16 v[64:67], v[208:211], a[192:195], v[116:119]
    v_exp_f32 v154, v58
    v_mfma_f32_16x16x32_bf16 v[68:71], v[224:227], a[192:195], v[116:119]
    v_exp_f32 v155, v59
    v_mfma_f32_16x16x32_bf16 v[64:67], v[212:215], a[196:199], v[64:67]
    v_cvt_pk_bf16_f32 v92, v152, v153
    v_cvt_pk_bf16_f32 v93, v154, v155
    v_mfma_f32_16x16x32_bf16 v[68:71], v[228:231], a[196:199], v[68:71]
    v_exp_f32 v156, v60
    v_mfma_f32_16x16x32_bf16 v[64:67], v[216:219], a[200:203], v[64:67]
    v_exp_f32 v157, v61
    v_mfma_f32_16x16x32_bf16 v[68:71], v[232:235], a[200:203], v[68:71]
    v_exp_f32 v158, v62
    v_mfma_f32_16x16x32_bf16 v[64:67], v[220:223], a[204:207], v[64:67]
    buffer_load_dwordx4 v11, s[20:23], s74 offen offset:3072 nt lds
    v_mfma_f32_16x16x32_bf16 v[68:71], v[236:239], a[204:207], v[68:71]
    s_add_u32 s89, s85, s59
    s_add_u32 s87, s85, 16384
    s_add_u32 s90, s86, s59
    v_mfma_f32_16x16x32_bf16 a[96:99], v[160:163], v[100:103], a[96:99]
    s_cmp_eq_u32 s87, 81920
    s_cselect_b32 s51, 0, s87
    s_sub_u32 s87, s51, s85
    v_mfma_f32_16x16x32_bf16 a[100:103], v[164:167], v[100:103], a[100:103]
    s_mov_b32 s85, s51
    s_add_u32 s88, s86, 16384
    s_add_u32 s57, s57, 8192
    v_mfma_f32_16x16x32_bf16 a[104:107], v[168:171], v[100:103], a[104:107]
    v_exp_f32 v159, v63
    v_mfma_f32_16x16x32_bf16 a[108:111], v[172:175], v[100:103], a[108:111]
    s_cmp_eq_u32 s88, 163840
    s_cselect_b32 s51, 81920, s88
    s_sub_u32 s88, s51, s86
    v_mfma_f32_16x16x32_bf16 a[112:115], v[176:179], v[100:103], a[112:115]
    s_mov_b32 s86, s51
    s_add_u32 s58, s58, 8192
    s_add_u32 s60, s60, 1
    v_cvt_pk_bf16_f32 v94, v156, v157
    v_cvt_pk_bf16_f32 v95, v158, v159
    v_mfma_f32_16x16x32_bf16 a[116:119], v[180:183], v[100:103], a[116:119]
    v_or3_b32 v44, v92, v93, v94
    v_or_b32 v44, v44, v95
    v_mfma_f32_16x16x32_bf16 a[120:123], v[184:187], v[100:103], a[120:123]
    v_exp_f32 v152, v64
    v_mfma_f32_16x16x32_bf16 a[124:127], v[188:191], v[100:103], a[124:127]
    v_exp_f32 v153, v65
    v_mfma_f32_16x16x32_bf16 v[140:143], v[148:151], v[100:103], v[140:143]
    v_add_u32 v23, s87, v23
    v_exp_f32 v154, v66
    v_add_u32 v24, s87, v24
    v_mfma_f32_16x16x32_bf16 v[72:75], v[208:211], a[208:211], v[120:123]
    v_add_u32 v25, s87, v25
    v_exp_f32 v155, v67
    v_add_u32 v26, s87, v26
    v_mfma_f32_16x16x32_bf16 v[76:79], v[224:227], a[208:211], v[120:123]
    v_cvt_pk_bf16_f32 v96, v152, v153
    v_add_u32 v27, s88, v27
    v_cvt_pk_bf16_f32 v97, v154, v155
    v_add_u32 v28, s88, v28
    v_mfma_f32_16x16x32_bf16 v[72:75], v[212:215], a[212:215], v[72:75]
    v_add_u32 v29, s88, v29
    v_exp_f32 v156, v68
    v_add_u32 v30, s88, v30
    v_mfma_f32_16x16x32_bf16 v[76:79], v[228:231], a[212:215], v[76:79]
    v_add_u32 v31, s88, v31
    v_exp_f32 v157, v69
    v_add_u32 v32, s88, v32
    v_mfma_f32_16x16x32_bf16 v[72:75], v[216:219], a[216:219], v[72:75]
    v_add_u32 v33, s88, v33
    v_exp_f32 v158, v70
    v_add_u32 v34, s88, v34
    v_mfma_f32_16x16x32_bf16 v[76:79], v[232:235], a[216:219], v[76:79]
    v_exp_f32 v159, v71
    v_mfma_f32_16x16x32_bf16 v[72:75], v[220:223], a[220:223], v[72:75]
    s_waitcnt vmcnt(20) lgkmcnt(0)
    s_barrier
    v_cvt_pk_bf16_f32 v98, v156, v157
    v_cvt_pk_bf16_f32 v99, v158, v159
    v_mfma_f32_16x16x32_bf16 v[76:79], v[236:239], a[220:223], v[76:79]
    v_or3_b32 v44, v44, v96, v97
    v_or3_b32 v44, v44, v98, v99
    s_waitcnt lgkmcnt(0)
    s_nop 15
L_AL:
    v_mfma_f32_16x16x32_bf16 a[128:131], v[160:163], v[104:107], a[128:131]
    v_and_b32 v45, 1073758208, v44
    v_cmp_ne_u32 vcc, 0, v45
    v_mfma_f32_16x16x32_bf16 a[132:135], v[164:167], v[104:107], a[132:135]
    ds_read_b64_tr_b16 v[160:161], v27 offset:0
    ds_read_b64_tr_b16 v[162:163], v27 offset:4096
    v_mfma_f32_16x16x32_bf16 a[136:139], v[168:171], v[104:107], a[136:139]
    ds_read_b64_tr_b16 v[164:165], v28 offset:0
    ds_read_b64_tr_b16 v[166:167], v28 offset:4096
    v_mfma_f32_16x16x32_bf16 a[140:143], v[172:175], v[104:107], a[140:143]
    s_cbranch_vccnz L_STUB3
L_RET3:
    ds_read_b64_tr_b16 v[168:169], v29 offset:0
    v_mfma_f32_16x16x32_bf16 a[144:147], v[176:179], v[104:107], a[144:147]
    ds_read_b64_tr_b16 v[170:171], v29 offset:4096
    ds_read_b64_tr_b16 v[172:173], v30 offset:0
    v_mfma_f32_16x16x32_bf16 a[148:151], v[180:183], v[104:107], a[148:151]
    ds_read_b64_tr_b16 v[174:175], v30 offset:4096
    ds_read_b64_tr_b16 v[176:177], v31 offset:0
    v_mfma_f32_16x16x32_bf16 a[152:155], v[184:187], v[104:107], a[152:155]
    ds_read_b64_tr_b16 v[178:179], v31 offset:4096
    ds_read_b64_tr_b16 v[180:181], v32 offset:0
    v_mfma_f32_16x16x32_bf16 a[156:159], v[188:191], v[104:107], a[156:159]
    ds_read_b64_tr_b16 v[182:183], v32 offset:4096
    ds_read_b64_tr_b16 v[184:185], v33 offset:0
    v_mfma_f32_16x16x32_bf16 v[144:147], v[148:151], v[104:107], v[144:147]
    ds_read_b64_tr_b16 v[186:187], v33 offset:4096
    ds_read_b64_tr_b16 v[188:189], v34 offset:0
    v_mfma_f32_16x16x32_bf16 v[80:83], v[208:211], a[224:227], v[124:127]
    ds_read_b64_tr_b16 v[190:191], v34 offset:4096
    ds_read_b128 v[208:211], v23 offset:0
    v_mfma_f32_16x16x32_bf16 v[84:87], v[224:227], a[224:227], v[124:127]
    s_cmp_lt_u32 s60, 11
    s_cselect_b32 s73, s57, 2130706432
    s_cselect_b32 m0, s89, 196608
    v_mfma_f32_16x16x32_bf16 v[80:83], v[212:215], a[228:231], v[80:83]
    ds_read_b128 v[224:227], v23 offset:4096
    ds_read_b128 v[212:215], v24 offset:0
    v_mfma_f32_16x16x32_bf16 v[84:87], v[228:231], a[228:231], v[84:87]
    v_exp_f32 v152, v72
    v_mfma_f32_16x16x32_bf16 v[80:83], v[216:219], a[232:235], v[80:83]
    ds_read_b128 v[228:231], v24 offset:4096
    ds_read_b128 v[216:219], v25 offset:0
    v_mfma_f32_16x16x32_bf16 v[84:87], v[232:235], a[232:235], v[84:87]
    ds_read_b128 v[232:235], v25 offset:4096
    buffer_load_dwordx4 v10, s[16:19], s73 offen offset:0 nt lds
    v_mfma_f32_16x16x32_bf16 v[80:83], v[220:223], a[236:239], v[80:83]
    v_exp_f32 v153, v73
    v_mfma_f32_16x16x32_bf16 v[84:87], v[236:239], a[236:239], v[84:87]
    s_waitcnt lgkmcnt(14)
    ds_read_b128 v[220:223], v26 offset:0
    v_mfma_f32_16x16x32_bf16 a[0:3], v[160:163], v[88:91], a[0:3]
    v_exp_f32 v154, v74
    v_mfma_f32_16x16x32_bf16 a[4:7], v[164:167], v[88:91], a[4:7]
    v_exp_f32 v155, v75
    v_mfma_f32_16x16x32_bf16 a[8:11], v[168:171], v[88:91], a[8:11]
    ds_read_b128 v[236:239], v26 offset:4096
    v_cvt_pk_bf16_f32 v100, v152, v153
    v_mfma_f32_16x16x32_bf16 a[12:15], v[172:175], v[88:91], a[12:15]
    s_waitcnt lgkmcnt(8)
    v_cvt_pk_bf16_f32 v101, v154, v155
    v_mfma_f32_16x16x32_bf16 a[16:19], v[176:179], v[88:91], a[16:19]
    v_exp_f32 v156, v76
    v_mfma_f32_16x16x32_bf16 a[20:23], v[180:183], v[88:91], a[20:23]
    v_exp_f32 v157, v77
    v_mfma_f32_16x16x32_bf16 a[24:27], v[184:187], v[88:91], a[24:27]
    v_exp_f32 v158, v78
    v_mfma_f32_16x16x32_bf16 a[28:31], v[188:191], v[88:91], a[28:31]
    v_exp_f32 v159, v79
    v_mfma_f32_16x16x32_bf16 v[128:131], v[148:151], v[88:91], v[128:131]
    s_waitcnt lgkmcnt(4)
    buffer_load_dwordx4 v11, s[16:19], s73 offen offset:1024 nt lds
    v_mfma_f32_16x16x32_bf16 v[48:51], v[208:211], a[160:163], v[108:111]
    v_cvt_pk_bf16_f32 v102, v156, v157
    v_cvt_pk_bf16_f32 v103, v158, v159
    v_mfma_f32_16x16x32_bf16 v[52:55], v[224:227], a[160:163], v[108:111]
    v_or3_b32 v43, v100, v101, v102
    v_or_b32 v43, v43, v103
    v_mfma_f32_16x16x32_bf16 v[48:51], v[212:215], a[164:167], v[48:51]
    v_exp_f32 v152, v80
    v_mfma_f32_16x16x32_bf16 v[52:55], v[228:231], a[164:167], v[52:55]
    s_waitcnt lgkmcnt(0)
    buffer_load_dwordx4 v10, s[16:19], s73 offen offset:2048 nt lds
    v_mfma_f32_16x16x32_bf16 v[48:51], v[216:219], a[168:171], v[48:51]
    v_exp_f32 v153, v81
    v_mfma_f32_16x16x32_bf16 v[52:55], v[232:235], a[168:171], v[52:55]
    v_exp_f32 v154, v82
    v_mfma_f32_16x16x32_bf16 v[48:51], v[220:223], a[172:175], v[48:51]
    v_exp_f32 v155, v83
    v_mfma_f32_16x16x32_bf16 v[52:55], v[236:239], a[172:175], v[52:55]
    v_cvt_pk_bf16_f32 v104, v152, v153
    v_cvt_pk_bf16_f32 v105, v154, v155
    v_mfma_f32_16x16x32_bf16 a[32:35], v[160:163], v[92:95], a[32:35]
    v_exp_f32 v156, v84
    v_mfma_f32_16x16x32_bf16 a[36:39], v[164:167], v[92:95], a[36:39]
    v_exp_f32 v157, v85
    v_mfma_f32_16x16x32_bf16 a[40:43], v[168:171], v[92:95], a[40:43]
    v_exp_f32 v158, v86
    v_mfma_f32_16x16x32_bf16 a[44:47], v[172:175], v[92:95], a[44:47]
    v_exp_f32 v159, v87
    v_mfma_f32_16x16x32_bf16 a[48:51], v[176:179], v[92:95], a[48:51]
    buffer_load_dwordx4 v11, s[16:19], s73 offen offset:3072 nt lds
    v_cvt_pk_bf16_f32 v106, v156, v157
    v_mfma_f32_16x16x32_bf16 a[52:55], v[180:183], v[92:95], a[52:55]
    v_cvt_pk_bf16_f32 v107, v158, v159
    v_or3_b32 v43, v43, v104, v105
    v_mfma_f32_16x16x32_bf16 a[56:59], v[184:187], v[92:95], a[56:59]
    s_cmp_lt_u32 s60, 12
    s_cselect_b32 s74, s58, 2130706432
    s_cselect_b32 m0, s90, 196608
    v_mfma_f32_16x16x32_bf16 a[60:63], v[188:191], v[92:95], a[60:63]
    v_or3_b32 v43, v43, v106, v107
    v_mfma_f32_16x16x32_bf16 v[132:135], v[148:151], v[92:95], v[132:135]
    v_exp_f32 v152, v48
    v_mfma_f32_16x16x32_bf16 v[56:59], v[208:211], a[176:179], v[112:115]
    v_exp_f32 v153, v49
    v_mfma_f32_16x16x32_bf16 v[60:63], v[224:227], a[176:179], v[112:115]
    v_exp_f32 v154, v50
    v_mfma_f32_16x16x32_bf16 v[56:59], v[212:215], a[180:183], v[56:59]
    v_exp_f32 v155, v51
    v_mfma_f32_16x16x32_bf16 v[60:63], v[228:231], a[180:183], v[60:63]
    v_cvt_pk_bf16_f32 v88, v152, v153
    v_cvt_pk_bf16_f32 v89, v154, v155
    v_mfma_f32_16x16x32_bf16 v[56:59], v[216:219], a[184:187], v[56:59]
    v_exp_f32 v156, v52
    v_mfma_f32_16x16x32_bf16 v[60:63], v[232:235], a[184:187], v[60:63]
    v_exp_f32 v157, v53
    v_mfma_f32_16x16x32_bf16 v[56:59], v[220:223], a[188:191], v[56:59]
    v_exp_f32 v158, v54
    v_mfma_f32_16x16x32_bf16 v[60:63], v[236:239], a[188:191], v[60:63]
    v_exp_f32 v159, v55
    v_mfma_f32_16x16x32_bf16 a[64:67], v[160:163], v[96:99], a[64:67]
    v_cvt_pk_bf16_f32 v90, v156, v157
    v_cvt_pk_bf16_f32 v91, v158, v159
    v_mfma_f32_16x16x32_bf16 a[68:71], v[164:167], v[96:99], a[68:71]
    buffer_load_dwordx4 v10, s[20:23], s74 offen offset:0 nt lds
    v_or3_b32 v43, v43, v88, v89
    v_mfma_f32_16x16x32_bf16 a[72:75], v[168:171], v[96:99], a[72:75]
    v_or3_b32 v43, v43, v90, v91
    v_and_b32 v45, 1073758208, v43
    v_mfma_f32_16x16x32_bf16 a[76:79], v[172:175], v[96:99], a[76:79]
    buffer_load_dwordx4 v11, s[20:23], s74 offen offset:1024 nt lds
    v_cmp_ne_u32 vcc, 0, v45
    v_mfma_f32_16x16x32_bf16 a[80:83], v[176:179], v[96:99], a[80:83]
    v_mfma_f32_16x16x32_bf16 a[84:87], v[180:183], v[96:99], a[84:87]
    buffer_load_dwordx4 v10, s[20:23], s74 offen offset:2048 nt lds
    v_mfma_f32_16x16x32_bf16 a[88:91], v[184:187], v[96:99], a[88:91]
    s_cbranch_vccnz L_STUB4
L_RET4:
    v_mfma_f32_16x16x32_bf16 a[92:95], v[188:191], v[96:99], a[92:95]
    v_exp_f32 v152, v56
    v_mfma_f32_16x16x32_bf16 v[136:139], v[148:151], v[96:99], v[136:139]
    v_exp_f32 v153, v57
    v_mfma_f32_16x16x32_bf16 v[64:67], v[208:211], a[192:195], v[116:119]
    v_exp_f32 v154, v58
    v_mfma_f32_16x16x32_bf16 v[68:71], v[224:227], a[192:195], v[116:119]
    v_exp_f32 v155, v59
    v_mfma_f32_16x16x32_bf16 v[64:67], v[212:215], a[196:199], v[64:67]
    v_cvt_pk_bf16_f32 v92, v152, v153
    v_cvt_pk_bf16_f32 v93, v154, v155
    v_mfma_f32_16x16x32_bf16 v[68:71], v[228:231], a[196:199], v[68:71]
    v_exp_f32 v156, v60
    v_mfma_f32_16x16x32_bf16 v[64:67], v[216:219], a[200:203], v[64:67]
    v_exp_f32 v157, v61
    v_mfma_f32_16x16x32_bf16 v[68:71], v[232:235], a[200:203], v[68:71]
    v_exp_f32 v158, v62
    v_mfma_f32_16x16x32_bf16 v[64:67], v[220:223], a[204:207], v[64:67]
    buffer_load_dwordx4 v11, s[20:23], s74 offen offset:3072 nt lds
    v_mfma_f32_16x16x32_bf16 v[68:71], v[236:239], a[204:207], v[68:71]
    s_add_u32 s89, s85, s59
    s_add_u32 s87, s85, 16384
    s_add_u32 s90, s86, s59
    v_mfma_f32_16x16x32_bf16 a[96:99], v[160:163], v[100:103], a[96:99]
    s_cmp_eq_u32 s87, 81920
    s_cselect_b32 s51, 0, s87
    s_sub_u32 s87, s51, s85
    v_mfma_f32_16x16x32_bf16 a[100:103], v[164:167], v[100:103], a[100:103]
    s_mov_b32 s85, s51
    s_add_u32 s88, s86, 16384
    s_add_u32 s57, s57, 8192
    v_mfma_f32_16x16x32_bf16 a[104:107], v[168:171], v[100:103], a[104:107]
    v_exp_f32 v159, v63
    v_mfma_f32_16x16x32_bf16 a[108:111], v[172:175], v[100:103], a[108:111]
    s_cmp_eq_u32 s88, 163840
    s_cselect_b32 s51, 81920, s88
    s_sub_u32 s88, s51, s86
    v_mfma_f32_16x16x32_bf16 a[112:115], v[176:179], v[100:103], a[112:115]
    s_mov_b32 s86, s51
    s_add_u32 s58, s58, 8192
    s_add_u32 s60, s60, 1
    v_cvt_pk_bf16_f32 v94, v156, v157
    v_cvt_pk_bf16_f32 v95, v158, v159
    v_mfma_f32_16x16x32_bf16 a[116:119], v[180:183], v[100:103], a[116:119]
    v_or3_b32 v44, v92, v93, v94
    v_or_b32 v44, v44, v95
    v_mfma_f32_16x16x32_bf16 a[120:123], v[184:187], v[100:103], a[120:123]
    v_exp_f32 v152, v64
    v_mfma_f32_16x16x32_bf16 a[124:127], v[188:191], v[100:103], a[124:127]
    v_exp_f32 v153, v65
    v_mfma_f32_16x16x32_bf16 v[140:143], v[148:151], v[100:103], v[140:143]
    v_add_u32 v23, s87, v23
    v_exp_f32 v154, v66
    v_add_u32 v24, s87, v24
    v_mfma_f32_16x16x32_bf16 v[72:75], v[208:211], a[208:211], v[120:123]
    v_add_u32 v25, s87, v25
    v_exp_f32 v155, v67
    v_add_u32 v26, s87, v26
    v_mfma_f32_16x16x32_bf16 v[76:79], v[224:227], a[208:211], v[120:123]
    v_cvt_pk_bf16_f32 v96, v152, v153
    v_add_u32 v27, s88, v27
    v_cvt_pk_bf16_f32 v97, v154, v155
    v_add_u32 v28, s88, v28
    v_mfma_f32_16x16x32_bf16 v[72:75], v[212:215], a[212:215], v[72:75]
    v_add_u32 v29, s88, v29
    v_exp_f32 v156, v68
    v_add_u32 v30, s88, v30
    v_mfma_f32_16x16x32_bf16 v[76:79], v[228:231], a[212:215], v[76:79]
    v_add_u32 v31, s88, v31
    v_exp_f32 v157, v69
    v_add_u32 v32, s88, v32
    v_mfma_f32_16x16x32_bf16 v[72:75], v[216:219], a[216:219], v[72:75]
    v_add_u32 v33, s88, v33
    v_exp_f32 v158, v70
    v_add_u32 v34, s88, v34
    v_mfma_f32_16x16x32_bf16 v[76:79], v[232:235], a[216:219], v[76:79]
    s_cmp_eq_u32 s60, s78
    s_cbranch_scc1 L_EVT
L_EVTR:
    v_exp_f32 v159, v71
    v_mfma_f32_16x16x32_bf16 v[72:75], v[220:223], a[220:223], v[72:75]
    s_waitcnt vmcnt(24) lgkmcnt(0)
    s_barrier
    v_cvt_pk_bf16_f32 v98, v156, v157
    v_cvt_pk_bf16_f32 v99, v158, v159
    v_mfma_f32_16x16x32_bf16 v[76:79], v[236:239], a[220:223], v[76:79]
    s_cmp_lt_u32 s60, 15
    v_or3_b32 v44, v44, v96, v97
    v_or3_b32 v44, v44, v98, v99
    s_cbranch_scc1 L_AL
    v_mov_b32 v252, 0
    s_cmp_lg_u32 s48, 0
    s_cbranch_scc1 L_NCK
    buffer_load_dword v250, v252, s[40:43], s83 offen sc1
    buffer_load_dword v251, v252, s[40:43], s63 offen sc1
L_NCK:
    s_mov_b32 s81, 0
    s_cmp_lt_u32 s48, 2
    s_cselect_b32 s87, 6, 0
    s_cselect_b32 s88, 10, 16
    s_add_u32 s51, s71, 1
    s_and_b32 s51, s51, 3
    s_lshl_b32 s51, s51, 2
    s_mul_i32 s51, s51, s62
    s_add_u32 s89, s75, s51
    s_lshl_b32 s51, s71, 2
    s_sub_u32 s85, 16, s51
    s_mul_i32 s51, s51, s62
    s_add_u32 s75, s75, s51
    s_lshl_b32 s86, s62, 4
    v_mfma_f32_16x16x32_bf16 a[128:131], v[160:163], v[104:107], a[128:131]
    v_and_b32 v45, 1073758208, v44
    v_cmp_ne_u32 vcc, 0, v45
    v_mfma_f32_16x16x32_bf16 a[132:135], v[164:167], v[104:107], a[132:135]
    ds_read_b64_tr_b16 v[160:161], v27 offset:0
    ds_read_b64_tr_b16 v[162:163], v27 offset:4096
    v_mfma_f32_16x16x32_bf16 a[136:139], v[168:171], v[104:107], a[136:139]
    ds_read_b64_tr_b16 v[164:165], v28 offset:0
    ds_read_b64_tr_b16 v[166:167], v28 offset:4096
    v_mfma_f32_16x16x32_bf16 a[140:143], v[172:175], v[104:107], a[140:143]
    s_cbranch_vccnz L_STUB5
L_RET5:
    ds_read_b64_tr_b16 v[168:169], v29 offset:0
    v_mfma_f32_16x16x32_bf16 a[144:147], v[176:179], v[104:107], a[144:147]
    v_exp_f32 v152, v72
    v_mfma_f32_16x16x32_bf16 a[148:151], v[180:183], v[104:107], a[148:151]
    v_exp_f32 v153, v73
    v_mfma_f32_16x16x32_bf16 a[152:155], v[184:187], v[104:107], a[152:155]
    ds_read_b64_tr_b16 v[170:171], v29 offset:4096
    ds_read_b64_tr_b16 v[172:173], v30 offset:0
    v_mfma_f32_16x16x32_bf16 a[156:159], v[188:191], v[104:107], a[156:159]
    v_exp_f32 v154, v74
    v_mfma_f32_16x16x32_bf16 v[144:147], v[148:151], v[104:107], v[144:147]
    ds_read_b64_tr_b16 v[174:175], v30 offset:4096
    ds_read_b64_tr_b16 v[176:177], v31 offset:0
    v_mfma_f32_16x16x32_bf16 v[80:83], v[208:211], a[224:227], v[124:127]
    v_exp_f32 v155, v75
    v_mfma_f32_16x16x32_bf16 v[84:87], v[224:227], a[224:227], v[124:127]
    ds_read_b64_tr_b16 v[178:179], v31 offset:4096
    v_cvt_pk_bf16_f32 v100, v152, v153
    v_mfma_f32_16x16x32_bf16 v[80:83], v[212:215], a[228:231], v[80:83]
    ds_read_b64_tr_b16 v[180:181], v32 offset:0
    v_cvt_pk_bf16_f32 v101, v154, v155
    v_mfma_f32_16x16x32_bf16 v[84:87], v[228:231], a[228:231], v[84:87]
    ds_read_b64_tr_b16 v[182:183], v32 offset:4096
    ds_read_b64_tr_b16 v[184:185], v33 offset:0
    v_mfma_f32_16x16x32_bf16 v[80:83], v[216:219], a[232:235], v[80:83]
    v_exp_f32 v156, v76
    v_mfma_f32_16x16x32_bf16 v[84:87], v[232:235], a[232:235], v[84:87]
    ds_read_b64_tr_b16 v[186:187], v33 offset:4096
    ds_read_b64_tr_b16 v[188:189], v34 offset:0
    v_mfma_f32_16x16x32_bf16 v[80:83], v[220:223], a[236:239], v[80:83]
    v_exp_f32 v157, v77
    v_mfma_f32_16x16x32_bf16 v[84:87], v[236:239], a[236:239], v[84:87]
    s_waitcnt lgkmcnt(7)
    ds_read_b64_tr_b16 v[190:191], v34 offset:4096
    v_mfma_f32_16x16x32_bf16 a[0:3], v[160:163], v[88:91], a[0:3]
    v_exp_f32 v158, v78
    v_mfma_f32_16x16x32_bf16 a[4:7], v[164:167], v[88:91], a[4:7]
    v_exp_f32 v159, v79
    v_mfma_f32_16x16x32_bf16 a[8:11], v[168:171], v[88:91], a[8:11]
    v_cvt_pk_bf16_f32 v102, v156, v157
    v_cvt_pk_bf16_f32 v103, v158, v159
    v_mfma_f32_16x16x32_bf16 a[12:15], v[172:175], v[88:91], a[12:15]
    s_waitcnt lgkmcnt(0)
    v_or3_b32 v43, v100, v101, v102
    v_mfma_f32_16x16x32_bf16 a[16:19], v[176:179], v[88:91], a[16:19]
    v_or_b32 v43, v43, v103
    v_mfma_f32_16x16x32_bf16 a[20:23], v[180:183], v[88:91], a[20:23]
    s_add_u32 s53, s76, 0
    s_sub_u32 s51, s81, s87
    s_cmp_lt_u32 s51, s88
    s_cselect_b32 s73, s75, 2130706432
    s_cselect_b32 s53, s53, 196608
    v_mfma_f32_16x16x32_bf16 a[24:27], v[184:187], v[88:91], a[24:27]
    s_add_u32 s75, s75, s62
    s_add_u32 s74, s73, s82
    v_exp_f32 v152, v80
    v_mfma_f32_16x16x32_bf16 a[28:31], v[188:191], v[88:91], a[28:31]
    s_add_u32 s81, s81, 1
    s_cmp_eq_u32 s81, s85
    s_cselect_b32 s51, s86, 0
    s_sub_u32 s75, s75, s51
    s_mov_b32 m0, s53
    v_exp_f32 v153, v81
    v_mfma_f32_16x16x32_bf16 v[128:131], v[148:151], v[88:91], v[128:131]
    buffer_load_dwordx4 v38, s[44:47], s73 offen offset:0 sc1 lds
    s_add_u32 m0, s53, 1024
    v_exp_f32 v154, v82
    v_mfma_f32_16x16x32_bf16 a[32:35], v[160:163], v[92:95], a[32:35]
    buffer_load_dwordx4 v39, s[44:47], s73 offen offset:0 sc1 lds
    s_add_u32 m0, s53, 2048
    v_exp_f32 v155, v83
    v_mfma_f32_16x16x32_bf16 a[36:39], v[164:167], v[92:95], a[36:39]
    buffer_load_dwordx4 v40, s[44:47], s73 offen offset:0 sc1 lds
    s_add_u32 m0, s53, 3072
    v_cvt_pk_bf16_f32 v104, v152, v153
    v_cvt_pk_bf16_f32 v105, v154, v155
    v_mfma_f32_16x16x32_bf16 a[40:43], v[168:171], v[92:95], a[40:43]
    buffer_load_dwordx4 v41, s[44:47], s73 offen offset:0 sc1 lds
    s_add_u32 m0, s53, 4096
    v_exp_f32 v156, v84
    v_mfma_f32_16x16x32_bf16 a[44:47], v[172:175], v[92:95], a[44:47]
    buffer_load_dwordx4 v42, s[44:47], s73 offen offset:0 sc1 lds
    s_add_u32 m0, s53, 5120
    v_exp_f32 v157, v85
    v_mfma_f32_16x16x32_bf16 a[48:51], v[176:179], v[92:95], a[48:51]
    buffer_load_dwordx4 v38, s[44:47], s74 offen offset:0 sc1 lds
    s_add_u32 m0, s53, 6144
    v_exp_f32 v158, v86
    v_mfma_f32_16x16x32_bf16 a[52:55], v[180:183], v[92:95], a[52:55]
    buffer_load_dwordx4 v39, s[44:47], s74 offen offset:0 sc1 lds
    s_add_u32 m0, s53, 7168
    v_exp_f32 v159, v87
    v_mfma_f32_16x16x32_bf16 a[56:59], v[184:187], v[92:95], a[56:59]
    buffer_load_dwordx4 v40, s[44:47], s74 offen offset:0 sc1 lds
    s_add_u32 m0, s53, 8192
    v_cvt_pk_bf16_f32 v106, v156, v157
    v_cvt_pk_bf16_f32 v107, v158, v159
    v_mfma_f32_16x16x32_bf16 a[60:63], v[188:191], v[92:95], a[60:63]
    buffer_load_dwordx4 v41, s[44:47], s74 offen offset:0 sc1 lds
    s_add_u32 m0, s53, 9216
    v_or3_b32 v43, v43, v104, v105
    v_or3_b32 v43, v43, v106, v107
    v_mfma_f32_16x16x32_bf16 v[132:135], v[148:151], v[92:95], v[132:135]
    buffer_load_dwordx4 v42, s[44:47], s74 offen offset:0 sc1 lds
    v_mfma_f32_16x16x32_bf16 a[64:67], v[160:163], v[96:99], a[64:67]
    s_add_u32 s53, s76, 40960
    s_sub_u32 s51, s81, s87
    s_cmp_lt_u32 s51, s88
    s_cselect_b32 s73, s75, 2130706432
    s_cselect_b32 s53, s53, 196608
    v_mfma_f32_16x16x32_bf16 a[68:71], v[164:167], v[96:99], a[68:71]
    s_add_u32 s75, s75, s62
    s_add_u32 s74, s73, s82
    v_mfma_f32_16x16x32_bf16 a[72:75], v[168:171], v[96:99], a[72:75]
    s_add_u32 s81, s81, 1
    s_cmp_eq_u32 s81, s85
    s_cselect_b32 s51, s86, 0
    s_sub_u32 s75, s75, s51
    s_mov_b32 m0, s53
    v_mfma_f32_16x16x32_bf16 a[76:79], v[172:175], v[96:99], a[76:79]
    buffer_load_dwordx4 v38, s[44:47], s73 offen offset:0 sc1 lds
    s_add_u32 m0, s53, 1024
    v_mfma_f32_16x16x32_bf16 a[80:83], v[176:179], v[96:99], a[80:83]
    buffer_load_dwordx4 v39, s[44:47], s73 offen offset:0 sc1 lds
    s_add_u32 m0, s53, 2048
    v_and_b32 v45, 1073758208, v43
    v_cmp_ne_u32 vcc, 0, v45
    v_mfma_f32_16x16x32_bf16 a[84:87], v[180:183], v[96:99], a[84:87]
    buffer_load_dwordx4 v40, s[44:47], s73 offen offset:0 sc1 lds
    s_add_u32 m0, s53, 3072
    v_mfma_f32_16x16x32_bf16 a[88:91], v[184:187], v[96:99], a[88:91]
    buffer_load_dwordx4 v41, s[44:47], s73 offen offset:0 sc1 lds
    s_add_u32 m0, s53, 4096
    v_mfma_f32_16x16x32_bf16 a[92:95], v[188:191], v[96:99], a[92:95]
    buffer_load_dwordx4 v42, s[44:47], s73 offen offset:0 sc1 lds
    s_add_u32 m0, s53, 5120
    v_mfma_f32_16x16x32_bf16 v[136:139], v[148:151], v[96:99], v[136:139]
    s_cbranch_vccnz L_STUB6
L_RET6:
    buffer_load_dwordx4 v38, s[44:47], s74 offen offset:0 sc1 lds
    s_add_u32 m0, s53, 6144
    v_mfma_f32_16x16x32_bf16 a[96:99], v[160:163], v[100:103], a[96:99]
    buffer_load_dwordx4 v39, s[44:47], s74 offen offset:0 sc1 lds
    s_add_u32 m0, s53, 7168
    v_mfma_f32_16x16x32_bf16 a[100:103], v[164:167], v[100:103], a[100:103]
    buffer_load_dwordx4 v40, s[44:47], s74 offen offset:0 sc1 lds
    s_add_u32 m0, s53, 8192
    v_mfma_f32_16x16x32_bf16 a[104:107], v[168:171], v[100:103], a[104:107]
    buffer_load_dwordx4 v41, s[44:47], s74 offen offset:0 sc1 lds
    s_add_u32 m0, s53, 9216
    v_mfma_f32_16x16x32_bf16 a[108:111], v[172:175], v[100:103], a[108:111]
    buffer_load_dwordx4 v42, s[44:47], s74 offen offset:0 sc1 lds
    v_mfma_f32_16x16x32_bf16 a[112:115], v[176:179], v[100:103], a[112:115]
    s_add_u32 s53, s76, 81920
    s_sub_u32 s51, s81, s87
    s_cmp_lt_u32 s51, s88
    s_cselect_b32 s73, s75, 2130706432
    s_cselect_b32 s53, s53, 196608
    v_mfma_f32_16x16x32_bf16 a[116:119], v[180:183], v[100:103], a[116:119]
    s_add_u32 s75, s75, s62
    s_add_u32 s74, s73, s82
    v_mfma_f32_16x16x32_bf16 a[120:123], v[184:187], v[100:103], a[120:123]
    s_add_u32 s81, s81, 1
    s_cmp_eq_u32 s81, s85
    s_cselect_b32 s51, s86, 0
    s_sub_u32 s75, s75, s51
    s_mov_b32 m0, s53
    v_mfma_f32_16x16x32_bf16 a[124:127], v[188:191], v[100:103], a[124:127]
    buffer_load_dwordx4 v38, s[44:47], s73 offen offset:0 sc1 lds
    s_add_u32 m0, s53, 1024
    v_mfma_f32_16x16x32_bf16 v[140:143], v[148:151], v[100:103], v[140:143]
    buffer_load_dwordx4 v39, s[44:47], s73 offen offset:0 sc1 lds
    s_add_u32 m0, s53, 2048
    v_mfma_f32_16x16x32_bf16 a[128:131], v[160:163], v[104:107], a[128:131]
    buffer_load_dwordx4 v40, s[44:47], s73 offen offset:0 sc1 lds
    s_add_u32 m0, s53, 3072
    v_mfma_f32_16x16x32_bf16 a[132:135], v[164:167], v[104:107], a[132:135]
    buffer_load_dwordx4 v41, s[44:47], s73 offen offset:0 sc1 lds
    s_add_u32 m0, s53, 4096
    v_mfma_f32_16x16x32_bf16 a[136:139], v[168:171], v[104:107], a[136:139]
    buffer_load_dwordx4 v42, s[44:47], s73 offen offset:0 sc1 lds
    s_add_u32 m0, s53, 5120
    v_mfma_f32_16x16x32_bf16 a[140:143], v[172:175], v[104:107], a[140:143]
    buffer_load_dwordx4 v38, s[44:47], s74 offen offset:0 sc1 lds
    s_add_u32 m0, s53, 6144
    v_mfma_f32_16x16x32_bf16 a[144:147], v[176:179], v[104:107], a[144:147]
    buffer_load_dwordx4 v39, s[44:47], s74 offen offset:0 sc1 lds
    s_add_u32 m0, s53, 7168
    v_mfma_f32_16x16x32_bf16 a[148:151], v[180:183], v[104:107], a[148:151]
    buffer_load_dwordx4 v40, s[44:47], s74 offen offset:0 sc1 lds
    s_add_u32 m0, s53, 8192
    v_mfma_f32_16x16x32_bf16 a[152:155], v[184:187], v[104:107], a[152:155]
    buffer_load_dwordx4 v41, s[44:47], s74 offen offset:0 sc1 lds
    s_add_u32 m0, s53, 9216
    v_mfma_f32_16x16x32_bf16 a[156:159], v[188:191], v[104:107], a[156:159]
    buffer_load_dwordx4 v42, s[44:47], s74 offen offset:0 sc1 lds
    v_mfma_f32_16x16x32_bf16 v[144:147], v[148:151], v[104:107], v[144:147]
    s_waitcnt vmcnt(0) lgkmcnt(0)
    s_mov_b32 s80, 0
    s_cmp_lg_u32 s48, 0
    s_cbranch_scc1 L_CHKD
L_CHK:
    v_readfirstlane_b32 s51, v250
    v_readfirstlane_b32 s52, v251
    s_and_b32 s51, s51, 255
    s_bfe_u32 s52, s52, 524296
    s_min_u32 s51, s51, s52
    s_cmp_ge_u32 s51, 4
    s_cbranch_scc1 L_CHKD
    s_add_u32 s80, s80, 1
    s_cmp_ge_u32 s80, 65536
    s_cbranch_scc1 L_CHKD
    s_sleep 8
    buffer_load_dword v250, v252, s[40:43], s83 offen sc1
    buffer_load_dword v251, v252, s[40:43], s63 offen sc1
    s_waitcnt vmcnt(0)
    s_branch L_CHK
L_CHKD:
    s_barrier
    s_lshl_b32 s83, s83, 5
    s_add_u32 s83, s83, 134217728
    s_lshl_b32 s63, s63, 5
    s_add_u32 s63, s63, 134225920
    s_mul_i32 s51, s50, 81920
    s_mul_i32 s52, s49, 10240
    s_add_u32 s51, s51, s52
    v_add_u32 v15, s51, v12
    v_rcp_f32 v240, v128
    v_rcp_f32 v241, v132
    v_rcp_f32 v242, v136
    v_rcp_f32 v243, v140
    v_rcp_f32 v244, v144
    v_accvgpr_read_b32 v208, a0
    v_accvgpr_read_b32 v212, a4
    v_accvgpr_read_b32 v209, a1
    v_accvgpr_read_b32 v213, a5
    v_accvgpr_read_b32 v210, a2
    v_accvgpr_read_b32 v214, a6
    v_accvgpr_read_b32 v211, a3
    v_accvgpr_read_b32 v215, a7
    v_mul_f32 v208, v240, v208
    v_mul_f32 v209, v240, v209
    v_mul_f32 v210, v240, v210
    v_mul_f32 v211, v240, v211
    v_mul_f32 v212, v240, v212
    v_mul_f32 v213, v240, v213
    v_mul_f32 v214, v240, v214
    v_mul_f32 v215, v240, v215
    v_cvt_pk_bf16_f32 v128, v208, v209
    v_cvt_pk_bf16_f32 v129, v210, v211
    v_cvt_pk_bf16_f32 v130, v212, v213
    v_cvt_pk_bf16_f32 v131, v214, v215
    ds_write_b128 v15, v[128:131] offset:0
    s_add_u32 s54, s61, 0
    buffer_store_dwordx4 v[128:131], v12, s[24:27], s54 offen sc1
    v_accvgpr_read_b32 v216, a8
    v_accvgpr_read_b32 v220, a12
    v_accvgpr_read_b32 v217, a9
    v_accvgpr_read_b32 v221, a13
    v_accvgpr_read_b32 v218, a10
    v_accvgpr_read_b32 v222, a14
    v_accvgpr_read_b32 v219, a11
    v_accvgpr_read_b32 v223, a15
    v_mul_f32 v216, v240, v216
    v_mul_f32 v217, v240, v217
    v_mul_f32 v218, v240, v218
    v_mul_f32 v219, v240, v219
    v_mul_f32 v220, v240, v220
    v_mul_f32 v221, v240, v221
    v_mul_f32 v222, v240, v222
    v_mul_f32 v223, v240, v223
    v_cvt_pk_bf16_f32 v132, v216, v217
    v_cvt_pk_bf16_f32 v133, v218, v219
    v_cvt_pk_bf16_f32 v134, v220, v221
    v_cvt_pk_bf16_f32 v135, v222, v223
    ds_write_b128 v15, v[132:135] offset:5120
    s_add_u32 s54, s61, 5120
    buffer_store_dwordx4 v[132:135], v12, s[24:27], s54 offen sc1
    v_accvgpr_read_b32 v224, a16
    v_accvgpr_read_b32 v228, a20
    v_accvgpr_read_b32 v225, a17
    v_accvgpr_read_b32 v229, a21
    v_accvgpr_read_b32 v226, a18
    v_accvgpr_read_b32 v230, a22
    v_accvgpr_read_b32 v227, a19
    v_accvgpr_read_b32 v231, a23
    v_mul_f32 v224, v240, v224
    v_mul_f32 v225, v240, v225
    v_mul_f32 v226, v240, v226
    v_mul_f32 v227, v240, v227
    v_mul_f32 v228, v240, v228
    v_mul_f32 v229, v240, v229
    v_mul_f32 v230, v240, v230
    v_mul_f32 v231, v240, v231
    v_cvt_pk_bf16_f32 v136, v224, v225
    v_cvt_pk_bf16_f32 v137, v226, v227
    v_cvt_pk_bf16_f32 v138, v228, v229
    v_cvt_pk_bf16_f32 v139, v230, v231
    ds_write_b128 v15, v[136:139] offset:40960
    s_add_u32 s54, s61, 10240
    buffer_store_dwordx4 v[136:139], v12, s[24:27], s54 offen sc1
    v_accvgpr_read_b32 v232, a24
    v_accvgpr_read_b32 v236, a28
    v_accvgpr_read_b32 v233, a25
    v_accvgpr_read_b32 v237, a29
    v_accvgpr_read_b32 v234, a26
    v_accvgpr_read_b32 v238, a30
    v_accvgpr_read_b32 v235, a27
    v_accvgpr_read_b32 v239, a31
    v_mul_f32 v232, v240, v232
    v_mul_f32 v233, v240, v233
    v_mul_f32 v234, v240, v234
    v_mul_f32 v235, v240, v235
    v_mul_f32 v236, v240, v236
    v_mul_f32 v237, v240, v237
    v_mul_f32 v238, v240, v238
    v_mul_f32 v239, v240, v239
    v_cvt_pk_bf16_f32 v140, v232, v233
    v_cvt_pk_bf16_f32 v141, v234, v235
    v_cvt_pk_bf16_f32 v142, v236, v237
    v_cvt_pk_bf16_f32 v143, v238, v239
    ds_write_b128 v15, v[140:143] offset:46080
    s_add_u32 s54, s61, 15360
    buffer_store_dwordx4 v[140:143], v12, s[24:27], s54 offen sc1
    v_accvgpr_read_b32 v208, a32
    v_accvgpr_read_b32 v212, a36
    v_accvgpr_read_b32 v209, a33
    v_accvgpr_read_b32 v213, a37
    v_accvgpr_read_b32 v210, a34
    v_accvgpr_read_b32 v214, a38
    v_accvgpr_read_b32 v211, a35
    v_accvgpr_read_b32 v215, a39
    v_mul_f32 v208, v241, v208
    v_mul_f32 v209, v241, v209
    v_mul_f32 v210, v241, v210
    v_mul_f32 v211, v241, v211
    v_mul_f32 v212, v241, v212
    v_mul_f32 v213, v241, v213
    v_mul_f32 v214, v241, v214
    v_mul_f32 v215, v241, v215
    v_cvt_pk_bf16_f32 v144, v208, v209
    v_cvt_pk_bf16_f32 v145, v210, v211
    v_cvt_pk_bf16_f32 v146, v212, v213
    v_cvt_pk_bf16_f32 v147, v214, v215
    ds_write_b128 v15, v[144:147] offset:1024
    s_add_u32 s54, s61, 1024
    buffer_store_dwordx4 v[144:147], v12, s[24:27], s54 offen sc1
    v_accvgpr_read_b32 v216, a40
    v_accvgpr_read_b32 v220, a44
    v_accvgpr_read_b32 v217, a41
    v_accvgpr_read_b32 v221, a45
    v_accvgpr_read_b32 v218, a42
    v_accvgpr_read_b32 v222, a46
    v_accvgpr_read_b32 v219, a43
    v_accvgpr_read_b32 v223, a47
    v_mul_f32 v216, v241, v216
    v_mul_f32 v217, v241, v217
    v_mul_f32 v218, v241, v218
    v_mul_f32 v219, v241, v219
    v_mul_f32 v220, v241, v220
    v_mul_f32 v221, v241, v221
    v_mul_f32 v222, v241, v222
    v_mul_f32 v223, v241, v223
    v_cvt_pk_bf16_f32 v148, v216, v217
    v_cvt_pk_bf16_f32 v149, v218, v219
    v_cvt_pk_bf16_f32 v150, v220, v221
    v_cvt_pk_bf16_f32 v151, v222, v223
    ds_write_b128 v15, v[148:151] offset:6144
    s_add_u32 s54, s61, 6144
    buffer_store_dwordx4 v[148:151], v12, s[24:27], s54 offen sc1
    v_accvgpr_read_b32 v224, a48
    v_accvgpr_read_b32 v228, a52
    v_accvgpr_read_b32 v225, a49
    v_accvgpr_read_b32 v229, a53
    v_accvgpr_read_b32 v226, a50
    v_accvgpr_read_b32 v230, a54
    v_accvgpr_read_b32 v227, a51
    v_accvgpr_read_b32 v231, a55
    v_mul_f32 v224, v241, v224
    v_mul_f32 v225, v241, v225
    v_mul_f32 v226, v241, v226
    v_mul_f32 v227, v241, v227
    v_mul_f32 v228, v241, v228
    v_mul_f32 v229, v241, v229
    v_mul_f32 v230, v241, v230
    v_mul_f32 v231, v241, v231
    v_cvt_pk_bf16_f32 v152, v224, v225
    v_cvt_pk_bf16_f32 v153, v226, v227
    v_cvt_pk_bf16_f32 v154, v228, v229
    v_cvt_pk_bf16_f32 v155, v230, v231
    ds_write_b128 v15, v[152:155] offset:41984
    s_add_u32 s54, s61, 11264
    buffer_store_dwordx4 v[152:155], v12, s[24:27], s54 offen sc1
    v_accvgpr_read_b32 v232, a56
    v_accvgpr_read_b32 v236, a60
    v_accvgpr_read_b32 v233, a57
    v_accvgpr_read_b32 v237, a61
    v_accvgpr_read_b32 v234, a58
    v_accvgpr_read_b32 v238, a62
    v_accvgpr_read_b32 v235, a59
    v_accvgpr_read_b32 v239, a63
    v_mul_f32 v232, v241, v232
    v_mul_f32 v233, v241, v233
    v_mul_f32 v234, v241, v234
    v_mul_f32 v235, v241, v235
    v_mul_f32 v236, v241, v236
    v_mul_f32 v237, v241, v237
    v_mul_f32 v238, v241, v238
    v_mul_f32 v239, v241, v239
    v_cvt_pk_bf16_f32 v156, v232, v233
    v_cvt_pk_bf16_f32 v157, v234, v235
    v_cvt_pk_bf16_f32 v158, v236, v237
    v_cvt_pk_bf16_f32 v159, v238, v239
    ds_write_b128 v15, v[156:159] offset:47104
    s_add_u32 s54, s61, 16384
    buffer_store_dwordx4 v[156:159], v12, s[24:27], s54 offen sc1
    v_accvgpr_read_b32 v208, a64
    v_accvgpr_read_b32 v212, a68
    v_accvgpr_read_b32 v209, a65
    v_accvgpr_read_b32 v213, a69
    v_accvgpr_read_b32 v210, a66
    v_accvgpr_read_b32 v214, a70
    v_accvgpr_read_b32 v211, a67
    v_accvgpr_read_b32 v215, a71
    v_mul_f32 v208, v242, v208
    v_mul_f32 v209, v242, v209
    v_mul_f32 v210, v242, v210
    v_mul_f32 v211, v242, v211
    v_mul_f32 v212, v242, v212
    v_mul_f32 v213, v242, v213
    v_mul_f32 v214, v242, v214
    v_mul_f32 v215, v242, v215
    v_cvt_pk_bf16_f32 v160, v208, v209
    v_cvt_pk_bf16_f32 v161, v210, v211
    v_cvt_pk_bf16_f32 v162, v212, v213
    v_cvt_pk_bf16_f32 v163, v214, v215
    ds_write_b128 v15, v[160:163] offset:2048
    s_add_u32 s54, s61, 2048
    buffer_store_dwordx4 v[160:163], v12, s[24:27], s54 offen sc1
    v_accvgpr_read_b32 v216, a72
    v_accvgpr_read_b32 v220, a76
    v_accvgpr_read_b32 v217, a73
    v_accvgpr_read_b32 v221, a77
    v_accvgpr_read_b32 v218, a74
    v_accvgpr_read_b32 v222, a78
    v_accvgpr_read_b32 v219, a75
    v_accvgpr_read_b32 v223, a79
    v_mul_f32 v216, v242, v216
    v_mul_f32 v217, v242, v217
    v_mul_f32 v218, v242, v218
    v_mul_f32 v219, v242, v219
    v_mul_f32 v220, v242, v220
    v_mul_f32 v221, v242, v221
    v_mul_f32 v222, v242, v222
    v_mul_f32 v223, v242, v223
    v_cvt_pk_bf16_f32 v164, v216, v217
    v_cvt_pk_bf16_f32 v165, v218, v219
    v_cvt_pk_bf16_f32 v166, v220, v221
    v_cvt_pk_bf16_f32 v167, v222, v223
    ds_write_b128 v15, v[164:167] offset:7168
    s_add_u32 s54, s61, 7168
    buffer_store_dwordx4 v[164:167], v12, s[24:27], s54 offen sc1
    v_accvgpr_read_b32 v224, a80
    v_accvgpr_read_b32 v228, a84
    v_accvgpr_read_b32 v225, a81
    v_accvgpr_read_b32 v229, a85
    v_accvgpr_read_b32 v226, a82
    v_accvgpr_read_b32 v230, a86
    v_accvgpr_read_b32 v227, a83
    v_accvgpr_read_b32 v231, a87
    v_mul_f32 v224, v242, v224
    v_mul_f32 v225, v242, v225
    v_mul_f32 v226, v242, v226
    v_mul_f32 v227, v242, v227
    v_mul_f32 v228, v242, v228
    v_mul_f32 v229, v242, v229
    v_mul_f32 v230, v242, v230
    v_mul_f32 v231, v242, v231
    v_cvt_pk_bf16_f32 v168, v224, v225
    v_cvt_pk_bf16_f32 v169, v226, v227
    v_cvt_pk_bf16_f32 v170, v228, v229
    v_cvt_pk_bf16_f32 v171, v230, v231
    ds_write_b128 v15, v[168:171] offset:43008
    s_add_u32 s54, s61, 12288
    buffer_store_dwordx4 v[168:171], v12, s[24:27], s54 offen sc1
    v_accvgpr_read_b32 v232, a88
    v_accvgpr_read_b32 v236, a92
    v_accvgpr_read_b32 v233, a89
    v_accvgpr_read_b32 v237, a93
    v_accvgpr_read_b32 v234, a90
    v_accvgpr_read_b32 v238, a94
    v_accvgpr_read_b32 v235, a91
    v_accvgpr_read_b32 v239, a95
    v_mul_f32 v232, v242, v232
    v_mul_f32 v233, v242, v233
    v_mul_f32 v234, v242, v234
    v_mul_f32 v235, v242, v235
    v_mul_f32 v236, v242, v236
    v_mul_f32 v237, v242, v237
    v_mul_f32 v238, v242, v238
    v_mul_f32 v239, v242, v239
    v_cvt_pk_bf16_f32 v172, v232, v233
    v_cvt_pk_bf16_f32 v173, v234, v235
    v_cvt_pk_bf16_f32 v174, v236, v237
    v_cvt_pk_bf16_f32 v175, v238, v239
    ds_write_b128 v15, v[172:175] offset:48128
    s_add_u32 s54, s61, 17408
    buffer_store_dwordx4 v[172:175], v12, s[24:27], s54 offen sc1
    v_accvgpr_read_b32 v208, a96
    v_accvgpr_read_b32 v212, a100
    v_accvgpr_read_b32 v209, a97
    v_accvgpr_read_b32 v213, a101
    v_accvgpr_read_b32 v210, a98
    v_accvgpr_read_b32 v214, a102
    v_accvgpr_read_b32 v211, a99
    v_accvgpr_read_b32 v215, a103
    v_mul_f32 v208, v243, v208
    v_mul_f32 v209, v243, v209
    v_mul_f32 v210, v243, v210
    v_mul_f32 v211, v243, v211
    v_mul_f32 v212, v243, v212
    v_mul_f32 v213, v243, v213
    v_mul_f32 v214, v243, v214
    v_mul_f32 v215, v243, v215
    v_cvt_pk_bf16_f32 v176, v208, v209
    v_cvt_pk_bf16_f32 v177, v210, v211
    v_cvt_pk_bf16_f32 v178, v212, v213
    v_cvt_pk_bf16_f32 v179, v214, v215
    ds_write_b128 v15, v[176:179] offset:3072
    s_add_u32 s54, s61, 3072
    buffer_store_dwordx4 v[176:179], v12, s[24:27], s54 offen sc1
    v_accvgpr_read_b32 v216, a104
    v_accvgpr_read_b32 v220, a108
    v_accvgpr_read_b32 v217, a105
    v_accvgpr_read_b32 v221, a109
    v_accvgpr_read_b32 v218, a106
    v_accvgpr_read_b32 v222, a110
    v_accvgpr_read_b32 v219, a107
    v_accvgpr_read_b32 v223, a111
    v_mul_f32 v216, v243, v216
    v_mul_f32 v217, v243, v217
    v_mul_f32 v218, v243, v218
    v_mul_f32 v219, v243, v219
    v_mul_f32 v220, v243, v220
    v_mul_f32 v221, v243, v221
    v_mul_f32 v222, v243, v222
    v_mul_f32 v223, v243, v223
    v_cvt_pk_bf16_f32 v180, v216, v217
    v_cvt_pk_bf16_f32 v181, v218, v219
    v_cvt_pk_bf16_f32 v182, v220, v221
    v_cvt_pk_bf16_f32 v183, v222, v223
    ds_write_b128 v15, v[180:183] offset:8192
    s_add_u32 s54, s61, 8192
    buffer_store_dwordx4 v[180:183], v12, s[24:27], s54 offen sc1
    v_accvgpr_read_b32 v224, a112
    v_accvgpr_read_b32 v228, a116
    v_accvgpr_read_b32 v225, a113
    v_accvgpr_read_b32 v229, a117
    v_accvgpr_read_b32 v226, a114
    v_accvgpr_read_b32 v230, a118
    v_accvgpr_read_b32 v227, a115
    v_accvgpr_read_b32 v231, a119
    v_mul_f32 v224, v243, v224
    v_mul_f32 v225, v243, v225
    v_mul_f32 v226, v243, v226
    v_mul_f32 v227, v243, v227
    v_mul_f32 v228, v243, v228
    v_mul_f32 v229, v243, v229
    v_mul_f32 v230, v243, v230
    v_mul_f32 v231, v243, v231
    v_cvt_pk_bf16_f32 v184, v224, v225
    v_cvt_pk_bf16_f32 v185, v226, v227
    v_cvt_pk_bf16_f32 v186, v228, v229
    v_cvt_pk_bf16_f32 v187, v230, v231
    ds_write_b128 v15, v[184:187] offset:44032
    s_add_u32 s54, s61, 13312
    buffer_store_dwordx4 v[184:187], v12, s[24:27], s54 offen sc1
    v_accvgpr_read_b32 v232, a120
    v_accvgpr_read_b32 v236, a124
    v_accvgpr_read_b32 v233, a121
    v_accvgpr_read_b32 v237, a125
    v_accvgpr_read_b32 v234, a122
    v_accvgpr_read_b32 v238, a126
    v_accvgpr_read_b32 v235, a123
    v_accvgpr_read_b32 v239, a127
    v_mul_f32 v232, v243, v232
    v_mul_f32 v233, v243, v233
    v_mul_f32 v234, v243, v234
    v_mul_f32 v235, v243, v235
    v_mul_f32 v236, v243, v236
    v_mul_f32 v237, v243, v237
    v_mul_f32 v238, v243, v238
    v_mul_f32 v239, v243, v239
    v_cvt_pk_bf16_f32 v188, v232, v233
    v_cvt_pk_bf16_f32 v189, v234, v235
    v_cvt_pk_bf16_f32 v190, v236, v237
    v_cvt_pk_bf16_f32 v191, v238, v239
    ds_write_b128 v15, v[188:191] offset:49152
    s_add_u32 s54, s61, 18432
    buffer_store_dwordx4 v[188:191], v12, s[24:27], s54 offen sc1
    v_accvgpr_read_b32 v208, a128
    v_accvgpr_read_b32 v212, a132
    v_accvgpr_read_b32 v209, a129
    v_accvgpr_read_b32 v213, a133
    v_accvgpr_read_b32 v210, a130
    v_accvgpr_read_b32 v214, a134
    v_accvgpr_read_b32 v211, a131
    v_accvgpr_read_b32 v215, a135
    v_mul_f32 v208, v244, v208
    v_mul_f32 v209, v244, v209
    v_mul_f32 v210, v244, v210
    v_mul_f32 v211, v244, v211
    v_mul_f32 v212, v244, v212
    v_mul_f32 v213, v244, v213
    v_mul_f32 v214, v244, v214
    v_mul_f32 v215, v244, v215
    v_cvt_pk_bf16_f32 v192, v208, v209
    v_cvt_pk_bf16_f32 v193, v210, v211
    v_cvt_pk_bf16_f32 v194, v212, v213
    v_cvt_pk_bf16_f32 v195, v214, v215
    ds_write_b128 v15, v[192:195] offset:4096
    s_add_u32 s54, s61, 4096
    buffer_store_dwordx4 v[192:195], v12, s[24:27], s54 offen sc1
    v_accvgpr_read_b32 v216, a136
    v_accvgpr_read_b32 v220, a140
    v_accvgpr_read_b32 v217, a137
    v_accvgpr_read_b32 v221, a141
    v_accvgpr_read_b32 v218, a138
    v_accvgpr_read_b32 v222, a142
    v_accvgpr_read_b32 v219, a139
    v_accvgpr_read_b32 v223, a143
    v_mul_f32 v216, v244, v216
    v_mul_f32 v217, v244, v217
    v_mul_f32 v218, v244, v218
    v_mul_f32 v219, v244, v219
    v_mul_f32 v220, v244, v220
    v_mul_f32 v221, v244, v221
    v_mul_f32 v222, v244, v222
    v_mul_f32 v223, v244, v223
    v_cvt_pk_bf16_f32 v196, v216, v217
    v_cvt_pk_bf16_f32 v197, v218, v219
    v_cvt_pk_bf16_f32 v198, v220, v221
    v_cvt_pk_bf16_f32 v199, v222, v223
    ds_write_b128 v15, v[196:199] offset:9216
    s_add_u32 s54, s61, 9216
    buffer_store_dwordx4 v[196:199], v12, s[24:27], s54 offen sc1
    v_accvgpr_read_b32 v224, a144
    v_accvgpr_read_b32 v228, a148
    v_accvgpr_read_b32 v225, a145
    v_accvgpr_read_b32 v229, a149
    v_accvgpr_read_b32 v226, a146
    v_accvgpr_read_b32 v230, a150
    v_accvgpr_read_b32 v227, a147
    v_accvgpr_read_b32 v231, a151
    v_mul_f32 v224, v244, v224
    v_mul_f32 v225, v244, v225
    v_mul_f32 v226, v244, v226
    v_mul_f32 v227, v244, v227
    v_mul_f32 v228, v244, v228
    v_mul_f32 v229, v244, v229
    v_mul_f32 v230, v244, v230
    v_mul_f32 v231, v244, v231
    v_cvt_pk_bf16_f32 v200, v224, v225
    v_cvt_pk_bf16_f32 v201, v226, v227
    v_cvt_pk_bf16_f32 v202, v228, v229
    v_cvt_pk_bf16_f32 v203, v230, v231
    ds_write_b128 v15, v[200:203] offset:45056
    s_add_u32 s54, s61, 14336
    buffer_store_dwordx4 v[200:203], v12, s[24:27], s54 offen sc1
    v_accvgpr_read_b32 v232, a152
    v_accvgpr_read_b32 v236, a156
    v_accvgpr_read_b32 v233, a153
    v_accvgpr_read_b32 v237, a157
    v_accvgpr_read_b32 v234, a154
    v_accvgpr_read_b32 v238, a158
    v_accvgpr_read_b32 v235, a155
    v_accvgpr_read_b32 v239, a159
    v_mul_f32 v232, v244, v232
    v_mul_f32 v233, v244, v233
    v_mul_f32 v234, v244, v234
    v_mul_f32 v235, v244, v235
    v_mul_f32 v236, v244, v236
    v_mul_f32 v237, v244, v237
    v_mul_f32 v238, v244, v238
    v_mul_f32 v239, v244, v239
    v_cvt_pk_bf16_f32 v204, v232, v233
    v_cvt_pk_bf16_f32 v205, v234, v235
    v_cvt_pk_bf16_f32 v206, v236, v237
    v_cvt_pk_bf16_f32 v207, v238, v239
    ds_write_b128 v15, v[204:207] offset:50176
    s_add_u32 s54, s61, 19456
    buffer_store_dwordx4 v[204:207], v12, s[24:27], s54 offen sc1
    s_mul_i32 s51, s49, 10240
    v_add_u32 v13, s51, v12
    v_lshrrev_b32 v4, 2, v3
    v_lshl_add_u32 v4, v2, 2, v4
    v_mul_u32_u24 v4, 320, v4
    v_and_b32 v5, 3, v3
    v_lshl_add_u32 v4, v5, 3, v4
    s_mul_i32 s51, s50, 160
    s_add_u32 s51, s51, 20480
    v_add_u32 v14, s51, v4
    s_mov_b32 s77, 0
    s_mov_b32 s79, 122880
    s_mov_b32 s60, 13
    s_waitcnt lgkmcnt(0)
    s_barrier
    s_waitcnt vmcnt(0)
    s_barrier
    s_lshl_b32 s51, s71, 2
    s_add_u32 s51, s51, s83
    s_cmp_lg_u32 s48, 0
    s_cbranch_scc1 L_NSO
    v_mov_b32 v4, 1
    v_mov_b32 v5, 0
    s_mov_b64 exec, 1
    buffer_store_dword v4, v5, s[32:35], s51 offen sc1
    s_mov_b64 exec, -1
L_NSO:
    ds_read_b128 v[48:51], v13 offset:0
    ds_read_b128 v[52:55], v13 offset:1024
    ds_read_b128 v[56:59], v13 offset:2048
    ds_read_b128 v[60:63], v13 offset:3072
    ds_read_b128 v[64:67], v13 offset:4096
    ds_read_b64_tr_b16 v[68:69], v14 offset:0
    ds_read_b64_tr_b16 v[70:71], v14 offset:5120
    ds_read_b64_tr_b16 v[72:73], v14 offset:32
    ds_read_b64_tr_b16 v[74:75], v14 offset:5152
    ds_read_b64_tr_b16 v[76:77], v14 offset:64
    ds_read_b64_tr_b16 v[78:79], v14 offset:5184
    ds_read_b64_tr_b16 v[80:81], v14 offset:96
    ds_read_b64_tr_b16 v[82:83], v14 offset:5216
    ds_read_b64_tr_b16 v[84:85], v14 offset:128
    ds_read_b64_tr_b16 v[86:87], v14 offset:5248
    s_waitcnt lgkmcnt(8)
    v_mfma_f32_16x16x32_bf16 a[0:3], v[68:71], v[48:51], 0
    ds_read_b128 v[88:91], v13 offset:5120
    ds_read_b128 v[92:95], v13 offset:6144
    v_mfma_f32_16x16x32_bf16 a[20:23], v[68:71], v[52:55], 0
    s_add_u32 s53, s76, s79
    s_sub_u32 s51, s81, s87
    s_cmp_lt_u32 s51, s88
    s_cselect_b32 s73, s75, 2130706432
    s_cselect_b32 s53, s53, 196608
    v_mfma_f32_16x16x32_bf16 a[40:43], v[68:71], v[56:59], 0
    s_add_u32 s75, s75, s62
    s_add_u32 s74, s73, s82
    v_mfma_f32_16x16x32_bf16 a[60:63], v[68:71], v[60:63], 0
    s_add_u32 s81, s81, 1
    s_cmp_eq_u32 s81, s85
    s_cselect_b32 s51, s86, 0
    s_sub_u32 s75, s75, s51
    s_mov_b32 m0, s53
    v_mfma_f32_16x16x32_bf16 a[80:83], v[68:71], v[64:67], 0
    buffer_load_dwordx4 v38, s[44:47], s73 offen offset:0 sc1 lds
    s_add_u32 m0, s53, 1024
    s_waitcnt lgkmcnt(8)
    v_mfma_f32_16x16x32_bf16 a[4:7], v[72:75], v[48:51], 0
    buffer_load_dwordx4 v39, s[44:47], s73 offen offset:0 sc1 lds
    s_add_u32 m0, s53, 2048
    v_mfma_f32_16x16x32_bf16 a[24:27], v[72:75], v[52:55], 0
    buffer_load_dwordx4 v40, s[44:47], s73 offen offset:0 sc1 lds
    s_add_u32 m0, s53, 3072
    v_mfma_f32_16x16x32_bf16 a[44:47], v[72:75], v[56:59], 0
    buffer_load_dwordx4 v41, s[44:47], s73 offen offset:0 sc1 lds
    s_add_u32 m0, s53, 4096
    v_mfma_f32_16x16x32_bf16 a[64:67], v[72:75], v[60:63], 0
    ds_read_b128 v[96:99], v13 offset:7168
    ds_read_b128 v[100:103], v13 offset:8192
    v_mfma_f32_16x16x32_bf16 a[84:87], v[72:75], v[64:67], 0
    ds_read_b128 v[104:107], v13 offset:9216
    ds_read_b64_tr_b16 v[108:109], v14 offset:10240
    s_waitcnt lgkmcnt(10)
    v_mfma_f32_16x16x32_bf16 a[8:11], v[76:79], v[48:51], 0
    buffer_load_dwordx4 v42, s[44:47], s73 offen offset:0 sc1 lds
    s_add_u32 m0, s53, 5120
    v_mfma_f32_16x16x32_bf16 a[28:31], v[76:79], v[52:55], 0
    ds_read_b64_tr_b16 v[110:111], v14 offset:15360
    ds_read_b64_tr_b16 v[112:113], v14 offset:10272
    v_mfma_f32_16x16x32_bf16 a[48:51], v[76:79], v[56:59], 0
    buffer_load_dwordx4 v38, s[44:47], s74 offen offset:0 sc1 lds
    s_add_u32 m0, s53, 6144
    v_mfma_f32_16x16x32_bf16 a[68:71], v[76:79], v[60:63], 0
    ds_read_b64_tr_b16 v[114:115], v14 offset:15392
    buffer_load_dwordx4 v39, s[44:47], s74 offen offset:0 sc1 lds
    s_add_u32 m0, s53, 7168
    v_mfma_f32_16x16x32_bf16 a[88:91], v[76:79], v[64:67], 0
    ds_read_b64_tr_b16 v[116:117], v14 offset:10304
    ds_read_b64_tr_b16 v[118:119], v14 offset:15424
    buffer_load_dwordx4 v40, s[44:47], s74 offen offset:0 sc1 lds
    s_add_u32 m0, s53, 8192
    s_waitcnt lgkmcnt(13)
    v_mfma_f32_16x16x32_bf16 a[12:15], v[80:83], v[48:51], 0
    ds_read_b64_tr_b16 v[120:121], v14 offset:10336
    ds_read_b64_tr_b16 v[122:123], v14 offset:15456
    buffer_load_dwordx4 v41, s[44:47], s74 offen offset:0 sc1 lds
    s_add_u32 m0, s53, 9216
    v_mfma_f32_16x16x32_bf16 a[32:35], v[80:83], v[52:55], 0
    ds_read_b64_tr_b16 v[124:125], v14 offset:10368
    ds_read_b64_tr_b16 v[126:127], v14 offset:15488
    buffer_load_dwordx4 v42, s[44:47], s74 offen offset:0 sc1 lds
    v_mfma_f32_16x16x32_bf16 a[52:55], v[80:83], v[56:59], 0
    v_mfma_f32_16x16x32_bf16 a[72:75], v[80:83], v[60:63], 0
    v_mfma_f32_16x16x32_bf16 a[92:95], v[80:83], v[64:67], 0
    s_add_u32 s79, s79, 40960
    s_cmp_eq_u32 s79, 163840
    s_cselect_b32 s79, 0, s79
    s_waitcnt lgkmcnt(15)
    v_mfma_f32_16x16x32_bf16 a[16:19], v[84:87], v[48:51], 0
    s_mov_b32 s78, s77
    s_add_u32 s77, s77, 40960
    s_cmp_eq_u32 s77, 163840
    s_cselect_b32 s77, 0, s77
    s_sub_u32 s78, s77, s78
    v_mfma_f32_16x16x32_bf16 a[36:39], v[84:87], v[52:55], 0
    v_add_u32 v13, s78, v13
    v_add_u32 v14, s78, v14
    v_mfma_f32_16x16x32_bf16 a[56:59], v[84:87], v[56:59], 0
    v_mfma_f32_16x16x32_bf16 a[76:79], v[84:87], v[60:63], 0
    s_waitcnt lgkmcnt(0)
    v_mfma_f32_16x16x32_bf16 a[96:99], v[84:87], v[64:67], 0
    v_mfma_f32_16x16x32_bf16 a[0:3], v[108:111], v[88:91], a[0:3]
    s_barrier
    v_mfma_f32_16x16x32_bf16 a[20:23], v[108:111], v[92:95], a[20:23]
    s_add_u32 s53, s76, s79
    s_sub_u32 s51, s81, s87
    s_cmp_lt_u32 s51, s88
    s_cselect_b32 s73, s75, 2130706432
    s_cselect_b32 s53, s53, 196608
    v_mfma_f32_16x16x32_bf16 a[40:43], v[108:111], v[96:99], a[40:43]
    ds_read_b128 v[48:51], v13 offset:0
    ds_read_b128 v[52:55], v13 offset:1024
    v_mfma_f32_16x16x32_bf16 a[60:63], v[108:111], v[100:103], a[60:63]
    ds_read_b128 v[56:59], v13 offset:2048
    ds_read_b128 v[60:63], v13 offset:3072
    v_mfma_f32_16x16x32_bf16 a[80:83], v[108:111], v[104:107], a[80:83]
    s_add_u32 s75, s75, s62
    s_add_u32 s74, s73, s82
    v_mfma_f32_16x16x32_bf16 a[4:7], v[112:115], v[88:91], a[4:7]
    ds_read_b128 v[64:67], v13 offset:4096
    ds_read_b64_tr_b16 v[68:69], v14 offset:0
    v_mfma_f32_16x16x32_bf16 a[24:27], v[112:115], v[92:95], a[24:27]
    ds_read_b64_tr_b16 v[70:71], v14 offset:5120
    ds_read_b64_tr_b16 v[72:73], v14 offset:32
    v_mfma_f32_16x16x32_bf16 a[44:47], v[112:115], v[96:99], a[44:47]
    s_add_u32 s81, s81, 1
    s_cmp_eq_u32 s81, s85
    s_cselect_b32 s51, s86, 0
    s_sub_u32 s75, s75, s51
    s_mov_b32 m0, s53
    v_mfma_f32_16x16x32_bf16 a[64:67], v[112:115], v[100:103], a[64:67]
    ds_read_b64_tr_b16 v[74:75], v14 offset:5152
    ds_read_b64_tr_b16 v[76:77], v14 offset:64
    v_mfma_f32_16x16x32_bf16 a[84:87], v[112:115], v[104:107], a[84:87]
    ds_read_b64_tr_b16 v[78:79], v14 offset:5184
    ds_read_b64_tr_b16 v[80:81], v14 offset:96
    v_mfma_f32_16x16x32_bf16 a[8:11], v[116:119], v[88:91], a[8:11]
    buffer_load_dwordx4 v38, s[44:47], s73 offen offset:0 sc1 lds
    s_add_u32 m0, s53, 1024
    v_mfma_f32_16x16x32_bf16 a[28:31], v[116:119], v[92:95], a[28:31]
    ds_read_b64_tr_b16 v[82:83], v14 offset:5216
    ds_read_b64_tr_b16 v[84:85], v14 offset:128
    v_mfma_f32_16x16x32_bf16 a[48:51], v[116:119], v[96:99], a[48:51]
    ds_read_b64_tr_b16 v[86:87], v14 offset:5248
    v_mfma_f32_16x16x32_bf16 a[68:71], v[116:119], v[100:103], a[68:71]
    buffer_load_dwordx4 v39, s[44:47], s73 offen offset:0 sc1 lds
    s_add_u32 m0, s53, 2048
    v_mfma_f32_16x16x32_bf16 a[88:91], v[116:119], v[104:107], a[88:91]
    v_mfma_f32_16x16x32_bf16 a[12:15], v[120:123], v[88:91], a[12:15]
    v_mfma_f32_16x16x32_bf16 a[32:35], v[120:123], v[92:95], a[32:35]
    buffer_load_dwordx4 v40, s[44:47], s73 offen offset:0 sc1 lds
    s_add_u32 m0, s53, 3072
    v_mfma_f32_16x16x32_bf16 a[52:55], v[120:123], v[96:99], a[52:55]
    v_mfma_f32_16x16x32_bf16 a[72:75], v[120:123], v[100:103], a[72:75]
    v_mfma_f32_16x16x32_bf16 a[92:95], v[120:123], v[104:107], a[92:95]
    buffer_load_dwordx4 v41, s[44:47], s73 offen offset:0 sc1 lds
    s_add_u32 m0, s53, 4096
    v_mfma_f32_16x16x32_bf16 a[16:19], v[124:127], v[88:91], a[16:19]
    v_mfma_f32_16x16x32_bf16 a[36:39], v[124:127], v[92:95], a[36:39]
    v_mfma_f32_16x16x32_bf16 a[56:59], v[124:127], v[96:99], a[56:59]
    buffer_load_dwordx4 v42, s[44:47], s73 offen offset:0 sc1 lds
    s_add_u32 m0, s53, 5120
    v_mfma_f32_16x16x32_bf16 a[76:79], v[124:127], v[100:103], a[76:79]
    s_waitcnt lgkmcnt(0)
    v_mfma_f32_16x16x32_bf16 a[96:99], v[124:127], v[104:107], a[96:99]
    v_mfma_f32_16x16x32_bf16 a[0:3], v[68:71], v[48:51], a[0:3]
    buffer_load_dwordx4 v38, s[44:47], s74 offen offset:0 sc1 lds
    s_add_u32 m0, s53, 6144
    v_mfma_f32_16x16x32_bf16 a[20:23], v[68:71], v[52:55], a[20:23]
    ds_read_b128 v[88:91], v13 offset:5120
    ds_read_b128 v[92:95], v13 offset:6144
    v_mfma_f32_16x16x32_bf16 a[40:43], v[68:71], v[56:59], a[40:43]
    ds_read_b128 v[96:99], v13 offset:7168
    ds_read_b128 v[100:103], v13 offset:8192
    v_mfma_f32_16x16x32_bf16 a[60:63], v[68:71], v[60:63], a[60:63]
    buffer_load_dwordx4 v39, s[44:47], s74 offen offset:0 sc1 lds
    s_add_u32 m0, s53, 7168
    v_mfma_f32_16x16x32_bf16 a[80:83], v[68:71], v[64:67], a[80:83]
    ds_read_b128 v[104:107], v13 offset:9216
    ds_read_b64_tr_b16 v[108:109], v14 offset:10240
    v_mfma_f32_16x16x32_bf16 a[4:7], v[72:75], v[48:51], a[4:7]
    ds_read_b64_tr_b16 v[110:111], v14 offset:15360
    ds_read_b64_tr_b16 v[112:113], v14 offset:10272
    v_mfma_f32_16x16x32_bf16 a[24:27], v[72:75], v[52:55], a[24:27]
    buffer_load_dwordx4 v40, s[44:47], s74 offen offset:0 sc1 lds
    s_add_u32 m0, s53, 8192
    v_mfma_f32_16x16x32_bf16 a[44:47], v[72:75], v[56:59], a[44:47]
    ds_read_b64_tr_b16 v[114:115], v14 offset:15392
    ds_read_b64_tr_b16 v[116:117], v14 offset:10304
    v_mfma_f32_16x16x32_bf16 a[64:67], v[72:75], v[60:63], a[64:67]
    ds_read_b64_tr_b16 v[118:119], v14 offset:15424
    ds_read_b64_tr_b16 v[120:121], v14 offset:10336
    v_mfma_f32_16x16x32_bf16 a[84:87], v[72:75], v[64:67], a[84:87]
    buffer_load_dwordx4 v41, s[44:47], s74 offen offset:0 sc1 lds
    s_add_u32 m0, s53, 9216
    v_mfma_f32_16x16x32_bf16 a[8:11], v[76:79], v[48:51], a[8:11]
    ds_read_b64_tr_b16 v[122:123], v14 offset:15456
    ds_read_b64_tr_b16 v[124:125], v14 offset:10368
    v_mfma_f32_16x16x32_bf16 a[28:31], v[76:79], v[52:55], a[28:31]
    ds_read_b64_tr_b16 v[126:127], v14 offset:15488
    v_mfma_f32_16x16x32_bf16 a[48:51], v[76:79], v[56:59], a[48:51]
    buffer_load_dwordx4 v42, s[44:47], s74 offen offset:0 sc1 lds
    v_mfma_f32_16x16x32_bf16 a[68:71], v[76:79], v[60:63], a[68:71]
    v_mfma_f32_16x16x32_bf16 a[88:91], v[76:79], v[64:67], a[88:91]
    v_mfma_f32_16x16x32_bf16 a[12:15], v[80:83], v[48:51], a[12:15]
    v_mfma_f32_16x16x32_bf16 a[32:35], v[80:83], v[52:55], a[32:35]
    v_mfma_f32_16x16x32_bf16 a[52:55], v[80:83], v[56:59], a[52:55]
    v_mfma_f32_16x16x32_bf16 a[72:75], v[80:83], v[60:63], a[72:75]
    v_mfma_f32_16x16x32_bf16 a[92:95], v[80:83], v[64:67], a[92:95]
    s_add_u32 s79, s79, 40960
    s_cmp_eq_u32 s79, 163840
    s_cselect_b32 s79, 0, s79
    v_mfma_f32_16x16x32_bf16 a[16:19], v[84:87], v[48:51], a[16:19]
    s_mov_b32 s78, s77
    s_add_u32 s77, s77, 40960
    s_cmp_eq_u32 s77, 163840
    s_cselect_b32 s77, 0, s77
    s_sub_u32 s78, s77, s78
    v_mfma_f32_16x16x32_bf16 a[36:39], v[84:87], v[52:55], a[36:39]
    v_add_u32 v13, s78, v13
    v_add_u32 v14, s78, v14
    v_mfma_f32_16x16x32_bf16 a[56:59], v[84:87], v[56:59], a[56:59]
    v_mfma_f32_16x16x32_bf16 a[76:79], v[84:87], v[60:63], a[76:79]
    s_waitcnt lgkmcnt(0)
    v_mfma_f32_16x16x32_bf16 a[96:99], v[84:87], v[64:67], a[96:99]
    v_mfma_f32_16x16x32_bf16 a[0:3], v[108:111], v[88:91], a[0:3]
    s_barrier
    v_mfma_f32_16x16x32_bf16 a[20:23], v[108:111], v[92:95], a[20:23]
    s_add_u32 s53, s76, s79
    s_sub_u32 s51, s81, s87
    s_cmp_lt_u32 s51, s88
    s_cselect_b32 s73, s75, 2130706432
    s_cselect_b32 s53, s53, 196608
    v_mfma_f32_16x16x32_bf16 a[40:43], v[108:111], v[96:99], a[40:43]
    ds_read_b128 v[48:51], v13 offset:0
    ds_read_b128 v[52:55], v13 offset:1024
    v_mfma_f32_16x16x32_bf16 a[60:63], v[108:111], v[100:103], a[60:63]
    ds_read_b128 v[56:59], v13 offset:2048
    ds_read_b128 v[60:63], v13 offset:3072
    v_mfma_f32_16x16x32_bf16 a[80:83], v[108:111], v[104:107], a[80:83]
    s_add_u32 s75, s75, s62
    s_add_u32 s74, s73, s82
    v_mfma_f32_16x16x32_bf16 a[4:7], v[112:115], v[88:91], a[4:7]
    ds_read_b128 v[64:67], v13 offset:4096
    ds_read_b64_tr_b16 v[68:69], v14 offset:0
    v_mfma_f32_16x16x32_bf16 a[24:27], v[112:115], v[92:95], a[24:27]
    ds_read_b64_tr_b16 v[70:71], v14 offset:5120
    ds_read_b64_tr_b16 v[72:73], v14 offset:32
    v_mfma_f32_16x16x32_bf16 a[44:47], v[112:115], v[96:99], a[44:47]
    s_add_u32 s81, s81, 1
    s_cmp_eq_u32 s81, s85
    s_cselect_b32 s51, s86, 0
    s_sub_u32 s75, s75, s51
    s_mov_b32 m0, s53
    v_mfma_f32_16x16x32_bf16 a[64:67], v[112:115], v[100:103], a[64:67]
    ds_read_b64_tr_b16 v[74:75], v14 offset:5152
    ds_read_b64_tr_b16 v[76:77], v14 offset:64
    v_mfma_f32_16x16x32_bf16 a[84:87], v[112:115], v[104:107], a[84:87]
    ds_read_b64_tr_b16 v[78:79], v14 offset:5184
    ds_read_b64_tr_b16 v[80:81], v14 offset:96
    v_mfma_f32_16x16x32_bf16 a[8:11], v[116:119], v[88:91], a[8:11]
    buffer_load_dwordx4 v38, s[44:47], s73 offen offset:0 sc1 lds
    s_add_u32 m0, s53, 1024
    v_mfma_f32_16x16x32_bf16 a[28:31], v[116:119], v[92:95], a[28:31]
    ds_read_b64_tr_b16 v[82:83], v14 offset:5216
    ds_read_b64_tr_b16 v[84:85], v14 offset:128
    v_mfma_f32_16x16x32_bf16 a[48:51], v[116:119], v[96:99], a[48:51]
    ds_read_b64_tr_b16 v[86:87], v14 offset:5248
    v_mfma_f32_16x16x32_bf16 a[68:71], v[116:119], v[100:103], a[68:71]
    buffer_load_dwordx4 v39, s[44:47], s73 offen offset:0 sc1 lds
    s_add_u32 m0, s53, 2048
    v_mfma_f32_16x16x32_bf16 a[88:91], v[116:119], v[104:107], a[88:91]
    v_mfma_f32_16x16x32_bf16 a[12:15], v[120:123], v[88:91], a[12:15]
    v_mfma_f32_16x16x32_bf16 a[32:35], v[120:123], v[92:95], a[32:35]
    buffer_load_dwordx4 v40, s[44:47], s73 offen offset:0 sc1 lds
    s_add_u32 m0, s53, 3072
    v_mfma_f32_16x16x32_bf16 a[52:55], v[120:123], v[96:99], a[52:55]
    v_mfma_f32_16x16x32_bf16 a[72:75], v[120:123], v[100:103], a[72:75]
    v_mfma_f32_16x16x32_bf16 a[92:95], v[120:123], v[104:107], a[92:95]
    buffer_load_dwordx4 v41, s[44:47], s73 offen offset:0 sc1 lds
    s_add_u32 m0, s53, 4096
    v_mfma_f32_16x16x32_bf16 a[16:19], v[124:127], v[88:91], a[16:19]
    v_mfma_f32_16x16x32_bf16 a[36:39], v[124:127], v[92:95], a[36:39]
    v_mfma_f32_16x16x32_bf16 a[56:59], v[124:127], v[96:99], a[56:59]
    buffer_load_dwordx4 v42, s[44:47], s73 offen offset:0 sc1 lds
    s_add_u32 m0, s53, 5120
    v_mfma_f32_16x16x32_bf16 a[76:79], v[124:127], v[100:103], a[76:79]
    s_waitcnt lgkmcnt(0)
    v_mfma_f32_16x16x32_bf16 a[96:99], v[124:127], v[104:107], a[96:99]
    v_mfma_f32_16x16x32_bf16 a[0:3], v[68:71], v[48:51], a[0:3]
    buffer_load_dwordx4 v38, s[44:47], s74 offen offset:0 sc1 lds
    s_add_u32 m0, s53, 6144
    v_mfma_f32_16x16x32_bf16 a[20:23], v[68:71], v[52:55], a[20:23]
    ds_read_b128 v[88:91], v13 offset:5120
    ds_read_b128 v[92:95], v13 offset:6144
    v_mfma_f32_16x16x32_bf16 a[40:43], v[68:71], v[56:59], a[40:43]
    ds_read_b128 v[96:99], v13 offset:7168
    ds_read_b128 v[100:103], v13 offset:8192
    v_mfma_f32_16x16x32_bf16 a[60:63], v[68:71], v[60:63], a[60:63]
    buffer_load_dwordx4 v39, s[44:47], s74 offen offset:0 sc1 lds
    s_add_u32 m0, s53, 7168
    v_mfma_f32_16x16x32_bf16 a[80:83], v[68:71], v[64:67], a[80:83]
    ds_read_b128 v[104:107], v13 offset:9216
    ds_read_b64_tr_b16 v[108:109], v14 offset:10240
    v_mfma_f32_16x16x32_bf16 a[4:7], v[72:75], v[48:51], a[4:7]
    ds_read_b64_tr_b16 v[110:111], v14 offset:15360
    ds_read_b64_tr_b16 v[112:113], v14 offset:10272
    v_mfma_f32_16x16x32_bf16 a[24:27], v[72:75], v[52:55], a[24:27]
    buffer_load_dwordx4 v40, s[44:47], s74 offen offset:0 sc1 lds
    s_add_u32 m0, s53, 8192
    v_mfma_f32_16x16x32_bf16 a[44:47], v[72:75], v[56:59], a[44:47]
    ds_read_b64_tr_b16 v[114:115], v14 offset:15392
    ds_read_b64_tr_b16 v[116:117], v14 offset:10304
    v_mfma_f32_16x16x32_bf16 a[64:67], v[72:75], v[60:63], a[64:67]
    ds_read_b64_tr_b16 v[118:119], v14 offset:15424
    ds_read_b64_tr_b16 v[120:121], v14 offset:10336
    v_mfma_f32_16x16x32_bf16 a[84:87], v[72:75], v[64:67], a[84:87]
    buffer_load_dwordx4 v41, s[44:47], s74 offen offset:0 sc1 lds
    s_add_u32 m0, s53, 9216
    v_mfma_f32_16x16x32_bf16 a[8:11], v[76:79], v[48:51], a[8:11]
    ds_read_b64_tr_b16 v[122:123], v14 offset:15456
    ds_read_b64_tr_b16 v[124:125], v14 offset:10368
    v_mfma_f32_16x16x32_bf16 a[28:31], v[76:79], v[52:55], a[28:31]
    ds_read_b64_tr_b16 v[126:127], v14 offset:15488
    v_mfma_f32_16x16x32_bf16 a[48:51], v[76:79], v[56:59], a[48:51]
    buffer_load_dwordx4 v42, s[44:47], s74 offen offset:0 sc1 lds
    v_mfma_f32_16x16x32_bf16 a[68:71], v[76:79], v[60:63], a[68:71]
    v_mfma_f32_16x16x32_bf16 a[88:91], v[76:79], v[64:67], a[88:91]
    v_mfma_f32_16x16x32_bf16 a[12:15], v[80:83], v[48:51], a[12:15]
    v_mfma_f32_16x16x32_bf16 a[32:35], v[80:83], v[52:55], a[32:35]
    v_mfma_f32_16x16x32_bf16 a[52:55], v[80:83], v[56:59], a[52:55]
    v_mfma_f32_16x16x32_bf16 a[72:75], v[80:83], v[60:63], a[72:75]
    v_mfma_f32_16x16x32_bf16 a[92:95], v[80:83], v[64:67], a[92:95]
    s_add_u32 s79, s79, 40960
    s_cmp_eq_u32 s79, 163840
    s_cselect_b32 s79, 0, s79
    v_mfma_f32_16x16x32_bf16 a[16:19], v[84:87], v[48:51], a[16:19]
    s_mov_b32 s78, s77
    s_add_u32 s77, s77, 40960
    s_cmp_eq_u32 s77, 163840
    s_cselect_b32 s77, 0, s77
    s_sub_u32 s78, s77, s78
    v_mfma_f32_16x16x32_bf16 a[36:39], v[84:87], v[52:55], a[36:39]
    v_add_u32 v13, s78, v13
    v_add_u32 v14, s78, v14
    v_mfma_f32_16x16x32_bf16 a[56:59], v[84:87], v[56:59], a[56:59]
    v_mfma_f32_16x16x32_bf16 a[76:79], v[84:87], v[60:63], a[76:79]
    s_waitcnt lgkmcnt(0)
    v_mfma_f32_16x16x32_bf16 a[96:99], v[84:87], v[64:67], a[96:99]
    s_cmp_ge_u32 s48, 2
    s_cbranch_scc1 L_NOPL
    v_mov_b32 v5, 0
    s_mov_b32 s80, 0
L_POLLO:
    buffer_load_dwordx4 v[248:251], v5, s[32:35], s83 offen sc1
    s_waitcnt vmcnt(0)
    v_and_b32 v248, v248, v249
    v_and_b32 v250, v250, v251
    v_and_b32 v248, v248, v250
    s_nop 0
    v_readfirstlane_b32 s52, v248
    s_add_u32 s80, s80, 1
    s_cmp_eq_u32 s52, 1
    s_cbranch_scc1 L_POLLDO
    s_cmp_ge_u32 s80, 65536
    s_cbranch_scc1 L_POLLDO
    s_sleep 2
    s_branch L_POLLO
L_POLLDO:
    s_add_u32 m0, s76, 0
    s_nop 0
    buffer_load_dwordx4 v38, s[44:47], s89 offen offset:0 sc1 lds
    s_add_u32 m0, s76, 1024
    s_nop 0
    buffer_load_dwordx4 v39, s[44:47], s89 offen offset:0 sc1 lds
    s_add_u32 m0, s76, 2048
    s_nop 0
    buffer_load_dwordx4 v40, s[44:47], s89 offen offset:0 sc1 lds
    s_add_u32 m0, s76, 3072
    s_nop 0
    buffer_load_dwordx4 v41, s[44:47], s89 offen offset:0 sc1 lds
    s_add_u32 m0, s76, 4096
    s_nop 0
    buffer_load_dwordx4 v42, s[44:47], s89 offen offset:0 sc1 lds
    s_add_u32 s89, s89, 5120
    s_add_u32 m0, s76, 5120
    s_nop 0
    buffer_load_dwordx4 v38, s[44:47], s89 offen offset:0 sc1 lds
    s_add_u32 m0, s76, 6144
    s_nop 0
    buffer_load_dwordx4 v39, s[44:47], s89 offen offset:0 sc1 lds
    s_add_u32 m0, s76, 7168
    s_nop 0
    buffer_load_dwordx4 v40, s[44:47], s89 offen offset:0 sc1 lds
    s_add_u32 m0, s76, 8192
    s_nop 0
    buffer_load_dwordx4 v41, s[44:47], s89 offen offset:0 sc1 lds
    s_add_u32 m0, s76, 9216
    s_nop 0
    buffer_load_dwordx4 v42, s[44:47], s89 offen offset:0 sc1 lds
    s_add_u32 s89, s89, 5120
    s_add_u32 m0, s76, 40960
    s_nop 0
    buffer_load_dwordx4 v38, s[44:47], s89 offen offset:0 sc1 lds
    s_add_u32 m0, s76, 41984
    s_nop 0
    buffer_load_dwordx4 v39, s[44:47], s89 offen offset:0 sc1 lds
    s_add_u32 m0, s76, 43008
    s_nop 0
    buffer_load_dwordx4 v40, s[44:47], s89 offen offset:0 sc1 lds
    s_add_u32 m0, s76, 44032
    s_nop 0
    buffer_load_dwordx4 v41, s[44:47], s89 offen offset:0 sc1 lds
    s_add_u32 m0, s76, 45056
    s_nop 0
    buffer_load_dwordx4 v42, s[44:47], s89 offen offset:0 sc1 lds
    s_add_u32 s89, s89, 5120
    s_add_u32 m0, s76, 46080
    s_nop 0
    buffer_load_dwordx4 v38, s[44:47], s89 offen offset:0 sc1 lds
    s_add_u32 m0, s76, 47104
    s_nop 0
    buffer_load_dwordx4 v39, s[44:47], s89 offen offset:0 sc1 lds
    s_add_u32 m0, s76, 48128
    s_nop 0
    buffer_load_dwordx4 v40, s[44:47], s89 offen offset:0 sc1 lds
    s_add_u32 m0, s76, 49152
    s_nop 0
    buffer_load_dwordx4 v41, s[44:47], s89 offen offset:0 sc1 lds
    s_add_u32 m0, s76, 50176
    s_nop 0
    buffer_load_dwordx4 v42, s[44:47], s89 offen offset:0 sc1 lds
L_NOPL:
    s_waitcnt lgkmcnt(0)
    s_nop 15
L_OPL:
    v_mfma_f32_16x16x32_bf16 a[0:3], v[108:111], v[88:91], a[0:3]
    s_waitcnt vmcnt(20)
    s_barrier
    v_mfma_f32_16x16x32_bf16 a[20:23], v[108:111], v[92:95], a[20:23]
    s_add_u32 s53, s76, s79
    s_sub_u32 s51, s81, s87
    s_cmp_lt_u32 s51, s88
    s_cselect_b32 s73, s75, 2130706432
    s_cselect_b32 s53, s53, 196608
    v_mfma_f32_16x16x32_bf16 a[40:43], v[108:111], v[96:99], a[40:43]
    ds_read_b128 v[48:51], v13 offset:0
    ds_read_b128 v[52:55], v13 offset:1024
    v_mfma_f32_16x16x32_bf16 a[60:63], v[108:111], v[100:103], a[60:63]
    ds_read_b128 v[56:59], v13 offset:2048
    ds_read_b128 v[60:63], v13 offset:3072
    v_mfma_f32_16x16x32_bf16 a[80:83], v[108:111], v[104:107], a[80:83]
    s_add_u32 s75, s75, s62
    s_add_u32 s74, s73, s82
    v_mfma_f32_16x16x32_bf16 a[4:7], v[112:115], v[88:91], a[4:7]
    ds_read_b128 v[64:67], v13 offset:4096
    ds_read_b64_tr_b16 v[68:69], v14 offset:0
    v_mfma_f32_16x16x32_bf16 a[24:27], v[112:115], v[92:95], a[24:27]
    ds_read_b64_tr_b16 v[70:71], v14 offset:5120
    ds_read_b64_tr_b16 v[72:73], v14 offset:32
    v_mfma_f32_16x16x32_bf16 a[44:47], v[112:115], v[96:99], a[44:47]
    s_add_u32 s81, s81, 1
    s_cmp_eq_u32 s81, s85
    s_cselect_b32 s51, s86, 0
    s_sub_u32 s75, s75, s51
    s_mov_b32 m0, s53
    v_mfma_f32_16x16x32_bf16 a[64:67], v[112:115], v[100:103], a[64:67]
    ds_read_b64_tr_b16 v[74:75], v14 offset:5152
    ds_read_b64_tr_b16 v[76:77], v14 offset:64
    v_mfma_f32_16x16x32_bf16 a[84:87], v[112:115], v[104:107], a[84:87]
    ds_read_b64_tr_b16 v[78:79], v14 offset:5184
    ds_read_b64_tr_b16 v[80:81], v14 offset:96
    v_mfma_f32_16x16x32_bf16 a[8:11], v[116:119], v[88:91], a[8:11]
    buffer_load_dwordx4 v38, s[44:47], s73 offen offset:0 sc1 lds
    s_add_u32 m0, s53, 1024
    v_mfma_f32_16x16x32_bf16 a[28:31], v[116:119], v[92:95], a[28:31]
    ds_read_b64_tr_b16 v[82:83], v14 offset:5216
    ds_read_b64_tr_b16 v[84:85], v14 offset:128
    v_mfma_f32_16x16x32_bf16 a[48:51], v[116:119], v[96:99], a[48:51]
    ds_read_b64_tr_b16 v[86:87], v14 offset:5248
    v_mfma_f32_16x16x32_bf16 a[68:71], v[116:119], v[100:103], a[68:71]
    buffer_load_dwordx4 v39, s[44:47], s73 offen offset:0 sc1 lds
    s_add_u32 m0, s53, 2048
    v_mfma_f32_16x16x32_bf16 a[88:91], v[116:119], v[104:107], a[88:91]
    v_mfma_f32_16x16x32_bf16 a[12:15], v[120:123], v[88:91], a[12:15]
    v_mfma_f32_16x16x32_bf16 a[32:35], v[120:123], v[92:95], a[32:35]
    buffer_load_dwordx4 v40, s[44:47], s73 offen offset:0 sc1 lds
    s_add_u32 m0, s53, 3072
    v_mfma_f32_16x16x32_bf16 a[52:55], v[120:123], v[96:99], a[52:55]
    v_mfma_f32_16x16x32_bf16 a[72:75], v[120:123], v[100:103], a[72:75]
    v_mfma_f32_16x16x32_bf16 a[92:95], v[120:123], v[104:107], a[92:95]
    buffer_load_dwordx4 v41, s[44:47], s73 offen offset:0 sc1 lds
    s_add_u32 m0, s53, 4096
    v_mfma_f32_16x16x32_bf16 a[16:19], v[124:127], v[88:91], a[16:19]
    v_mfma_f32_16x16x32_bf16 a[36:39], v[124:127], v[92:95], a[36:39]
    v_mfma_f32_16x16x32_bf16 a[56:59], v[124:127], v[96:99], a[56:59]
    buffer_load_dwordx4 v42, s[44:47], s73 offen offset:0 sc1 lds
    s_add_u32 m0, s53, 5120
    v_mfma_f32_16x16x32_bf16 a[76:79], v[124:127], v[100:103], a[76:79]
    s_waitcnt lgkmcnt(0)
    v_mfma_f32_16x16x32_bf16 a[96:99], v[124:127], v[104:107], a[96:99]
    v_mfma_f32_16x16x32_bf16 a[0:3], v[68:71], v[48:51], a[0:3]
    buffer_load_dwordx4 v38, s[44:47], s74 offen offset:0 sc1 lds
    s_add_u32 m0, s53, 6144
    v_mfma_f32_16x16x32_bf16 a[20:23], v[68:71], v[52:55], a[20:23]
    ds_read_b128 v[88:91], v13 offset:5120
    ds_read_b128 v[92:95], v13 offset:6144
    v_mfma_f32_16x16x32_bf16 a[40:43], v[68:71], v[56:59], a[40:43]
    ds_read_b128 v[96:99], v13 offset:7168
    ds_read_b128 v[100:103], v13 offset:8192
    v_mfma_f32_16x16x32_bf16 a[60:63], v[68:71], v[60:63], a[60:63]
    buffer_load_dwordx4 v39, s[44:47], s74 offen offset:0 sc1 lds
    s_add_u32 m0, s53, 7168
    v_mfma_f32_16x16x32_bf16 a[80:83], v[68:71], v[64:67], a[80:83]
    ds_read_b128 v[104:107], v13 offset:9216
    ds_read_b64_tr_b16 v[108:109], v14 offset:10240
    v_mfma_f32_16x16x32_bf16 a[4:7], v[72:75], v[48:51], a[4:7]
    ds_read_b64_tr_b16 v[110:111], v14 offset:15360
    ds_read_b64_tr_b16 v[112:113], v14 offset:10272
    v_mfma_f32_16x16x32_bf16 a[24:27], v[72:75], v[52:55], a[24:27]
    buffer_load_dwordx4 v40, s[44:47], s74 offen offset:0 sc1 lds
    s_add_u32 m0, s53, 8192
    v_mfma_f32_16x16x32_bf16 a[44:47], v[72:75], v[56:59], a[44:47]
    ds_read_b64_tr_b16 v[114:115], v14 offset:15392
    ds_read_b64_tr_b16 v[116:117], v14 offset:10304
    v_mfma_f32_16x16x32_bf16 a[64:67], v[72:75], v[60:63], a[64:67]
    ds_read_b64_tr_b16 v[118:119], v14 offset:15424
    ds_read_b64_tr_b16 v[120:121], v14 offset:10336
    v_mfma_f32_16x16x32_bf16 a[84:87], v[72:75], v[64:67], a[84:87]
    buffer_load_dwordx4 v41, s[44:47], s74 offen offset:0 sc1 lds
    s_add_u32 m0, s53, 9216
    v_mfma_f32_16x16x32_bf16 a[8:11], v[76:79], v[48:51], a[8:11]
    ds_read_b64_tr_b16 v[122:123], v14 offset:15456
    ds_read_b64_tr_b16 v[124:125], v14 offset:10368
    v_mfma_f32_16x16x32_bf16 a[28:31], v[76:79], v[52:55], a[28:31]
    ds_read_b64_tr_b16 v[126:127], v14 offset:15488
    v_mfma_f32_16x16x32_bf16 a[48:51], v[76:79], v[56:59], a[48:51]
    buffer_load_dwordx4 v42, s[44:47], s74 offen offset:0 sc1 lds
    v_mfma_f32_16x16x32_bf16 a[68:71], v[76:79], v[60:63], a[68:71]
    v_mfma_f32_16x16x32_bf16 a[88:91], v[76:79], v[64:67], a[88:91]
    v_mfma_f32_16x16x32_bf16 a[12:15], v[80:83], v[48:51], a[12:15]
    v_mfma_f32_16x16x32_bf16 a[32:35], v[80:83], v[52:55], a[32:35]
    v_mfma_f32_16x16x32_bf16 a[52:55], v[80:83], v[56:59], a[52:55]
    v_mfma_f32_16x16x32_bf16 a[72:75], v[80:83], v[60:63], a[72:75]
    v_mfma_f32_16x16x32_bf16 a[92:95], v[80:83], v[64:67], a[92:95]
    s_add_u32 s79, s79, 40960
    s_cmp_eq_u32 s79, 163840
    s_cselect_b32 s79, 0, s79
    v_mfma_f32_16x16x32_bf16 a[16:19], v[84:87], v[48:51], a[16:19]
    s_mov_b32 s78, s77
    s_add_u32 s77, s77, 40960
    s_cmp_eq_u32 s77, 163840
    s_cselect_b32 s77, 0, s77
    s_sub_u32 s78, s77, s78
    v_mfma_f32_16x16x32_bf16 a[36:39], v[84:87], v[52:55], a[36:39]
    v_add_u32 v13, s78, v13
    v_add_u32 v14, s78, v14
    v_mfma_f32_16x16x32_bf16 a[56:59], v[84:87], v[56:59], a[56:59]
    v_mfma_f32_16x16x32_bf16 a[76:79], v[84:87], v[60:63], a[76:79]
    s_waitcnt lgkmcnt(0)
    v_mfma_f32_16x16x32_bf16 a[96:99], v[84:87], v[64:67], a[96:99]
    s_sub_u32 s60, s60, 1
    s_cmp_lg_u32 s60, 0
    s_cbranch_scc1 L_OPL
    v_mfma_f32_16x16x32_bf16 a[0:3], v[108:111], v[88:91], a[0:3]
    v_mfma_f32_16x16x32_bf16 a[20:23], v[108:111], v[92:95], a[20:23]
    v_mfma_f32_16x16x32_bf16 a[40:43], v[108:111], v[96:99], a[40:43]
    v_mfma_f32_16x16x32_bf16 a[60:63], v[108:111], v[100:103], a[60:63]
    v_mfma_f32_16x16x32_bf16 a[80:83], v[108:111], v[104:107], a[80:83]
    v_mfma_f32_16x16x32_bf16 a[4:7], v[112:115], v[88:91], a[4:7]
    v_mfma_f32_16x16x32_bf16 a[24:27], v[112:115], v[92:95], a[24:27]
    v_mfma_f32_16x16x32_bf16 a[44:47], v[112:115], v[96:99], a[44:47]
    v_mfma_f32_16x16x32_bf16 a[64:67], v[112:115], v[100:103], a[64:67]
    v_mfma_f32_16x16x32_bf16 a[84:87], v[112:115], v[104:107], a[84:87]
    v_mfma_f32_16x16x32_bf16 a[8:11], v[116:119], v[88:91], a[8:11]
    v_mfma_f32_16x16x32_bf16 a[28:31], v[116:119], v[92:95], a[28:31]
    v_mfma_f32_16x16x32_bf16 a[48:51], v[116:119], v[96:99], a[48:51]
    v_mfma_f32_16x16x32_bf16 a[68:71], v[116:119], v[100:103], a[68:71]
    v_mfma_f32_16x16x32_bf16 a[88:91], v[116:119], v[104:107], a[88:91]
    v_mfma_f32_16x16x32_bf16 a[12:15], v[120:123], v[88:91], a[12:15]
    v_mfma_f32_16x16x32_bf16 a[32:35], v[120:123], v[92:95], a[32:35]
    v_mfma_f32_16x16x32_bf16 a[52:55], v[120:123], v[96:99], a[52:55]
    v_mfma_f32_16x16x32_bf16 a[72:75], v[120:123], v[100:103], a[72:75]
    v_mfma_f32_16x16x32_bf16 a[92:95], v[120:123], v[104:107], a[92:95]
    v_mfma_f32_16x16x32_bf16 a[16:19], v[124:127], v[88:91], a[16:19]
    v_mfma_f32_16x16x32_bf16 a[36:39], v[124:127], v[92:95], a[36:39]
    v_mfma_f32_16x16x32_bf16 a[56:59], v[124:127], v[96:99], a[56:59]
    v_mfma_f32_16x16x32_bf16 a[76:79], v[124:127], v[100:103], a[76:79]
    v_mfma_f32_16x16x32_bf16 a[96:99], v[124:127], v[104:107], a[96:99]
    s_lshl_b32 s51, s67, 3
    s_add_u32 s51, s51, s68
    s_lshl_b32 s51, s51, 2
    s_add_u32 s54, s51, s71
    s_lshl_b32 s51, s54, 2
    s_add_u32 s52, s51, s48
    s_lshl_b32 s52, s52, 2
    s_add_u32 s52, s52, s70
    s_mul_i32 s52, s52, 13312
    s_add_u32 s61, s52, 100663296
    s_add_u32 s52, s51, s70
    s_mul_i32 s52, s52, 53248
    s_add_u32 s75, s52, 100663296
    v_accvgpr_read_b32 v48, a0
    v_accvgpr_read_b32 v49, a1
    v_accvgpr_read_b32 v50, a2
    v_accvgpr_read_b32 v51, a3
    v_accvgpr_read_b32 v52, a4
    v_accvgpr_read_b32 v53, a5
    v_accvgpr_read_b32 v54, a6
    v_accvgpr_read_b32 v55, a7
    v_cvt_pk_bf16_f32 v56, v48, v49
    v_cvt_pk_bf16_f32 v57, v50, v51
    v_cvt_pk_bf16_f32 v58, v52, v53
    v_cvt_pk_bf16_f32 v59, v54, v55
    s_add_u32 s53, s61, 0
    buffer_store_dwordx4 v[56:59], v12, s[32:35], s53 offen offset:0 sc1
    v_accvgpr_read_b32 v60, a8
    v_accvgpr_read_b32 v61, a9
    v_accvgpr_read_b32 v62, a10
    v_accvgpr_read_b32 v63, a11
    v_accvgpr_read_b32 v64, a12
    v_accvgpr_read_b32 v65, a13
    v_accvgpr_read_b32 v66, a14
    v_accvgpr_read_b32 v67, a15
    v_cvt_pk_bf16_f32 v68, v60, v61
    v_cvt_pk_bf16_f32 v69, v62, v63
    v_cvt_pk_bf16_f32 v70, v64, v65
    v_cvt_pk_bf16_f32 v71, v66, v67
    buffer_store_dwordx4 v[68:71], v12, s[32:35], s53 offen offset:1024 sc1
    v_accvgpr_read_b32 v72, a16
    v_accvgpr_read_b32 v73, a17
    v_accvgpr_read_b32 v74, a18
    v_accvgpr_read_b32 v75, a19
    v_accvgpr_read_b32 v76, a20
    v_accvgpr_read_b32 v77, a21
    v_accvgpr_read_b32 v78, a22
    v_accvgpr_read_b32 v79, a23
    v_cvt_pk_bf16_f32 v80, v72, v73
    v_cvt_pk_bf16_f32 v81, v74, v75
    v_cvt_pk_bf16_f32 v82, v76, v77
    v_cvt_pk_bf16_f32 v83, v78, v79
    buffer_store_dwordx4 v[80:83], v12, s[32:35], s53 offen offset:2048 sc1
    v_accvgpr_read_b32 v84, a24
    v_accvgpr_read_b32 v85, a25
    v_accvgpr_read_b32 v86, a26
    v_accvgpr_read_b32 v87, a27
    v_accvgpr_read_b32 v88, a28
    v_accvgpr_read_b32 v89, a29
    v_accvgpr_read_b32 v90, a30
    v_accvgpr_read_b32 v91, a31
    v_cvt_pk_bf16_f32 v92, v84, v85
    v_cvt_pk_bf16_f32 v93, v86, v87
    v_cvt_pk_bf16_f32 v94, v88, v89
    v_cvt_pk_bf16_f32 v95, v90, v91
    buffer_store_dwordx4 v[92:95], v12, s[32:35], s53 offen offset:3072 sc1
    v_accvgpr_read_b32 v48, a32
    v_accvgpr_read_b32 v49, a33
    v_accvgpr_read_b32 v50, a34
    v_accvgpr_read_b32 v51, a35
    v_accvgpr_read_b32 v52, a36
    v_accvgpr_read_b32 v53, a37
    v_accvgpr_read_b32 v54, a38
    v_accvgpr_read_b32 v55, a39
    v_cvt_pk_bf16_f32 v56, v48, v49
    v_cvt_pk_bf16_f32 v57, v50, v51
    v_cvt_pk_bf16_f32 v58, v52, v53
    v_cvt_pk_bf16_f32 v59, v54, v55
    s_add_u32 s53, s61, 4096
    buffer_store_dwordx4 v[56:59], v12, s[32:35], s53 offen offset:0 sc1
    v_accvgpr_read_b32 v60, a40
    v_accvgpr_read_b32 v61, a41
    v_accvgpr_read_b32 v62, a42
    v_accvgpr_read_b32 v63, a43
    v_accvgpr_read_b32 v64, a44
    v_accvgpr_read_b32 v65, a45
    v_accvgpr_read_b32 v66, a46
    v_accvgpr_read_b32 v67, a47
    v_cvt_pk_bf16_f32 v68, v60, v61
    v_cvt_pk_bf16_f32 v69, v62, v63
    v_cvt_pk_bf16_f32 v70, v64, v65
    v_cvt_pk_bf16_f32 v71, v66, v67
    buffer_store_dwordx4 v[68:71], v12, s[32:35], s53 offen offset:1024 sc1
    v_accvgpr_read_b32 v72, a48
    v_accvgpr_read_b32 v73, a49
    v_accvgpr_read_b32 v74, a50
    v_accvgpr_read_b32 v75, a51
    v_accvgpr_read_b32 v76, a52
    v_accvgpr_read_b32 v77, a53
    v_accvgpr_read_b32 v78, a54
    v_accvgpr_read_b32 v79, a55
    v_cvt_pk_bf16_f32 v80, v72, v73
    v_cvt_pk_bf16_f32 v81, v74, v75
    v_cvt_pk_bf16_f32 v82, v76, v77
    v_cvt_pk_bf16_f32 v83, v78, v79
    buffer_store_dwordx4 v[80:83], v12, s[32:35], s53 offen offset:2048 sc1
    v_accvgpr_read_b32 v84, a56
    v_accvgpr_read_b32 v85, a57
    v_accvgpr_read_b32 v86, a58
    v_accvgpr_read_b32 v87, a59
    v_accvgpr_read_b32 v88, a60
    v_accvgpr_read_b32 v89, a61
    v_accvgpr_read_b32 v90, a62
    v_accvgpr_read_b32 v91, a63
    v_cvt_pk_bf16_f32 v92, v84, v85
    v_cvt_pk_bf16_f32 v93, v86, v87
    v_cvt_pk_bf16_f32 v94, v88, v89
    v_cvt_pk_bf16_f32 v95, v90, v91
    buffer_store_dwordx4 v[92:95], v12, s[32:35], s53 offen offset:3072 sc1
    v_accvgpr_read_b32 v48, a64
    v_accvgpr_read_b32 v49, a65
    v_accvgpr_read_b32 v50, a66
    v_accvgpr_read_b32 v51, a67
    v_accvgpr_read_b32 v52, a68
    v_accvgpr_read_b32 v53, a69
    v_accvgpr_read_b32 v54, a70
    v_accvgpr_read_b32 v55, a71
    v_cvt_pk_bf16_f32 v56, v48, v49
    v_cvt_pk_bf16_f32 v57, v50, v51
    v_cvt_pk_bf16_f32 v58, v52, v53
    v_cvt_pk_bf16_f32 v59, v54, v55
    s_add_u32 s53, s61, 8192
    buffer_store_dwordx4 v[56:59], v12, s[32:35], s53 offen offset:0 sc1
    v_accvgpr_read_b32 v60, a72
    v_accvgpr_read_b32 v61, a73
    v_accvgpr_read_b32 v62, a74
    v_accvgpr_read_b32 v63, a75
    v_accvgpr_read_b32 v64, a76
    v_accvgpr_read_b32 v65, a77
    v_accvgpr_read_b32 v66, a78
    v_accvgpr_read_b32 v67, a79
    v_cvt_pk_bf16_f32 v68, v60, v61
    v_cvt_pk_bf16_f32 v69, v62, v63
    v_cvt_pk_bf16_f32 v70, v64, v65
    v_cvt_pk_bf16_f32 v71, v66, v67
    buffer_store_dwordx4 v[68:71], v12, s[32:35], s53 offen offset:1024 sc1
    v_accvgpr_read_b32 v72, a80
    v_accvgpr_read_b32 v73, a81
    v_accvgpr_read_b32 v74, a82
    v_accvgpr_read_b32 v75, a83
    v_accvgpr_read_b32 v76, a84
    v_accvgpr_read_b32 v77, a85
    v_accvgpr_read_b32 v78, a86
    v_accvgpr_read_b32 v79, a87
    v_cvt_pk_bf16_f32 v80, v72, v73
    v_cvt_pk_bf16_f32 v81, v74, v75
    v_cvt_pk_bf16_f32 v82, v76, v77
    v_cvt_pk_bf16_f32 v83, v78, v79
    buffer_store_dwordx4 v[80:83], v12, s[32:35], s53 offen offset:2048 sc1
    v_accvgpr_read_b32 v84, a88
    v_accvgpr_read_b32 v85, a89
    v_accvgpr_read_b32 v86, a90
    v_accvgpr_read_b32 v87, a91
    v_accvgpr_read_b32 v88, a92
    v_accvgpr_read_b32 v89, a93
    v_accvgpr_read_b32 v90, a94
    v_accvgpr_read_b32 v91, a95
    v_cvt_pk_bf16_f32 v92, v84, v85
    v_cvt_pk_bf16_f32 v93, v86, v87
    v_cvt_pk_bf16_f32 v94, v88, v89
    v_cvt_pk_bf16_f32 v95, v90, v91
    buffer_store_dwordx4 v[92:95], v12, s[32:35], s53 offen offset:3072 sc1
    v_accvgpr_read_b32 v48, a96
    v_accvgpr_read_b32 v49, a97
    v_accvgpr_read_b32 v50, a98
    v_accvgpr_read_b32 v51, a99
    v_cvt_pk_bf16_f32 v56, v48, v49
    v_cvt_pk_bf16_f32 v57, v50, v51
    s_add_u32 s53, s61, 12288
    buffer_store_dwordx4 v[56:59], v12, s[32:35], s53 offen offset:0 sc1
    s_lshl_b32 s51, s48, 4
    s_lshl_b32 s52, s70, 2
    s_add_u32 s51, s51, s52
    s_add_u32 s51, s51, s63
    s_lshl_b32 s54, s70, 4
    s_add_u32 s54, s54, s63
    s_waitcnt vmcnt(0)
    v_mov_b32 v4, 1
    v_mov_b32 v5, 0
    s_mov_b64 exec, 1
    buffer_store_dword v4, v5, s[32:35], s51 offen sc1
    s_mov_b64 exec, -1
L_NSF:
    v_mov_b32 v5, 0
    s_mov_b32 s80, 0
L_POLLF:
    buffer_load_dwordx4 v[248:251], v5, s[32:35], s54 offen sc1
    s_waitcnt vmcnt(0)
    v_and_b32 v248, v248, v249
    v_and_b32 v250, v250, v251
    v_and_b32 v248, v248, v250
    s_nop 0
    v_readfirstlane_b32 s52, v248
    s_add_u32 s80, s80, 1
    s_cmp_eq_u32 s52, 1
    s_cbranch_scc1 L_POLLDF
    s_cmp_ge_u32 s80, 65536
    s_cbranch_scc1 L_POLLDF
    s_sleep 2
    s_branch L_POLLF
L_POLLDF:
    s_lshl_b32 s51, s48, 10
    s_add_u32 s75, s75, s51
    s_add_u32 s51, s75, 0
    buffer_load_dwordx4 v[48:51], v12, s[32:35], s51 offen sc1
    s_add_u32 s51, s75, 13312
    buffer_load_dwordx4 v[52:55], v12, s[32:35], s51 offen sc1
    s_add_u32 s51, s75, 26624
    buffer_load_dwordx4 v[56:59], v12, s[32:35], s51 offen sc1
    s_add_u32 s51, s75, 39936
    buffer_load_dwordx4 v[60:63], v12, s[32:35], s51 offen sc1
    s_add_u32 s51, s75, 4096
    buffer_load_dwordx4 v[64:67], v12, s[32:35], s51 offen sc1
    s_add_u32 s51, s75, 17408
    buffer_load_dwordx4 v[68:71], v12, s[32:35], s51 offen sc1
    s_add_u32 s51, s75, 30720
    buffer_load_dwordx4 v[72:75], v12, s[32:35], s51 offen sc1
    s_add_u32 s51, s75, 44032
    buffer_load_dwordx4 v[76:79], v12, s[32:35], s51 offen sc1
    s_add_u32 s51, s75, 8192
    buffer_load_dwordx4 v[80:83], v12, s[32:35], s51 offen sc1
    s_add_u32 s51, s75, 21504
    buffer_load_dwordx4 v[84:87], v12, s[32:35], s51 offen sc1
    s_add_u32 s51, s75, 34816
    buffer_load_dwordx4 v[88:91], v12, s[32:35], s51 offen sc1
    s_add_u32 s51, s75, 48128
    buffer_load_dwordx4 v[92:95], v12, s[32:35], s51 offen sc1
    s_add_u32 s51, s75, 12288
    buffer_load_dwordx4 v[96:99], v12, s[32:35], s51 offen sc1
    s_add_u32 s51, s75, 25600
    buffer_load_dwordx4 v[100:103], v12, s[32:35], s51 offen sc1
    s_add_u32 s51, s75, 38912
    buffer_load_dwordx4 v[104:107], v12, s[32:35], s51 offen sc1
    s_add_u32 s51, s75, 52224
    buffer_load_dwordx4 v[108:111], v12, s[32:35], s51 offen sc1
    v_mul_u32_u24 v16, 2560, v3
    v_lshl_add_u32 v16, v2, 3, v16
    s_waitcnt vmcnt(12)
    v_lshlrev_b32 v176, 16, v48
    v_and_b32 v177, 4294901760, v48
    v_lshlrev_b32 v178, 16, v49
    v_and_b32 v179, 4294901760, v49
    v_lshlrev_b32 v180, 16, v50
    v_and_b32 v181, 4294901760, v50
    v_lshlrev_b32 v182, 16, v51
    v_and_b32 v183, 4294901760, v51
    v_lshlrev_b32 v4, 16, v52
    v_and_b32 v5, 4294901760, v52
    v_add_f32 v176, v176, v4
    v_add_f32 v177, v177, v5
    v_lshlrev_b32 v4, 16, v53
    v_and_b32 v5, 4294901760, v53
    v_add_f32 v178, v178, v4
    v_add_f32 v179, v179, v5
    v_lshlrev_b32 v4, 16, v54
    v_and_b32 v5, 4294901760, v54
    v_add_f32 v180, v180, v4
    v_add_f32 v181, v181, v5
    v_lshlrev_b32 v4, 16, v55
    v_and_b32 v5, 4294901760, v55
    v_add_f32 v182, v182, v4
    v_add_f32 v183, v183, v5
    v_lshlrev_b32 v4, 16, v56
    v_and_b32 v5, 4294901760, v56
    v_add_f32 v176, v176, v4
    v_add_f32 v177, v177, v5
    v_lshlrev_b32 v4, 16, v57
    v_and_b32 v5, 4294901760, v57
    v_add_f32 v178, v178, v4
    v_add_f32 v179, v179, v5
    v_lshlrev_b32 v4, 16, v58
    v_and_b32 v5, 4294901760, v58
    v_add_f32 v180, v180, v4
    v_add_f32 v181, v181, v5
    v_lshlrev_b32 v4, 16, v59
    v_and_b32 v5, 4294901760, v59
    v_add_f32 v182, v182, v4
    v_add_f32 v183, v183, v5
    v_lshlrev_b32 v4, 16, v60
    v_and_b32 v5, 4294901760, v60
    v_add_f32 v176, v176, v4
    v_add_f32 v177, v177, v5
    v_lshlrev_b32 v4, 16, v61
    v_and_b32 v5, 4294901760, v61
    v_add_f32 v178, v178, v4
    v_add_f32 v179, v179, v5
    v_lshlrev_b32 v4, 16, v62
    v_and_b32 v5, 4294901760, v62
    v_add_f32 v180, v180, v4
    v_add_f32 v181, v181, v5
    v_lshlrev_b32 v4, 16, v63
    v_and_b32 v5, 4294901760, v63
    v_add_f32 v182, v182, v4
    v_add_f32 v183, v183, v5
    v_cvt_pk_bf16_f32 v184, v176, v177
    v_cvt_pk_bf16_f32 v185, v178, v179
    v_cvt_pk_bf16_f32 v186, v180, v181
    v_cvt_pk_bf16_f32 v187, v182, v183
    s_lshl_b32 s51, s48, 1
    s_add_u32 s51, s51, 0
    s_mul_i32 s52, s51, 52429
    s_lshr_b32 s52, s52, 18
    s_mul_i32 s53, s52, 5
    s_sub_u32 s53, s51, s53
    s_mul_i32 s52, s52, 40960
    s_lshl_b32 s53, s53, 5
    s_add_u32 s52, s52, s53
    buffer_store_dwordx2 v[184:185], v16, s[36:39], s52 offen
    s_lshl_b32 s51, s48, 1
    s_add_u32 s51, s51, 1
    s_mul_i32 s52, s51, 52429
    s_lshr_b32 s52, s52, 18
    s_mul_i32 s53, s52, 5
    s_sub_u32 s53, s51, s53
    s_mul_i32 s52, s52, 40960
    s_lshl_b32 s53, s53, 5
    s_add_u32 s52, s52, s53
    buffer_store_dwordx2 v[186:187], v16, s[36:39], s52 offen
    s_waitcnt vmcnt(10)
    v_lshlrev_b32 v176, 16, v64
    v_and_b32 v177, 4294901760, v64
    v_lshlrev_b32 v178, 16, v65
    v_and_b32 v179, 4294901760, v65
    v_lshlrev_b32 v180, 16, v66
    v_and_b32 v181, 4294901760, v66
    v_lshlrev_b32 v182, 16, v67
    v_and_b32 v183, 4294901760, v67
    v_lshlrev_b32 v4, 16, v68
    v_and_b32 v5, 4294901760, v68
    v_add_f32 v176, v176, v4
    v_add_f32 v177, v177, v5
    v_lshlrev_b32 v4, 16, v69
    v_and_b32 v5, 4294901760, v69
    v_add_f32 v178, v178, v4
    v_add_f32 v179, v179, v5
    v_lshlrev_b32 v4, 16, v70
    v_and_b32 v5, 4294901760, v70
    v_add_f32 v180, v180, v4
    v_add_f32 v181, v181, v5
    v_lshlrev_b32 v4, 16, v71
    v_and_b32 v5, 4294901760, v71
    v_add_f32 v182, v182, v4
    v_add_f32 v183, v183, v5
    v_lshlrev_b32 v4, 16, v72
    v_and_b32 v5, 4294901760, v72
    v_add_f32 v176, v176, v4
    v_add_f32 v177, v177, v5
    v_lshlrev_b32 v4, 16, v73
    v_and_b32 v5, 4294901760, v73
    v_add_f32 v178, v178, v4
    v_add_f32 v179, v179, v5
    v_lshlrev_b32 v4, 16, v74
    v_and_b32 v5, 4294901760, v74
    v_add_f32 v180, v180, v4
    v_add_f32 v181, v181, v5
    v_lshlrev_b32 v4, 16, v75
    v_and_b32 v5, 4294901760, v75
    v_add_f32 v182, v182, v4
    v_add_f32 v183, v183, v5
    v_lshlrev_b32 v4, 16, v76
    v_and_b32 v5, 4294901760, v76
    v_add_f32 v176, v176, v4
    v_add_f32 v177, v177, v5
    v_lshlrev_b32 v4, 16, v77
    v_and_b32 v5, 4294901760, v77
    v_add_f32 v178, v178, v4
    v_add_f32 v179, v179, v5
    v_lshlrev_b32 v4, 16, v78
    v_and_b32 v5, 4294901760, v78
    v_add_f32 v180, v180, v4
    v_add_f32 v181, v181, v5
    v_lshlrev_b32 v4, 16, v79
    v_and_b32 v5, 4294901760, v79
    v_add_f32 v182, v182, v4
    v_add_f32 v183, v183, v5
    v_cvt_pk_bf16_f32 v188, v176, v177
    v_cvt_pk_bf16_f32 v189, v178, v179
    v_cvt_pk_bf16_f32 v190, v180, v181
    v_cvt_pk_bf16_f32 v191, v182, v183
    s_lshl_b32 s51, s48, 1
    s_add_u32 s51, s51, 8
    s_mul_i32 s52, s51, 52429
    s_lshr_b32 s52, s52, 18
    s_mul_i32 s53, s52, 5
    s_sub_u32 s53, s51, s53
    s_mul_i32 s52, s52, 40960
    s_lshl_b32 s53, s53, 5
    s_add_u32 s52, s52, s53
    buffer_store_dwordx2 v[188:189], v16, s[36:39], s52 offen
    s_lshl_b32 s51, s48, 1
    s_add_u32 s51, s51, 9
    s_mul_i32 s52, s51, 52429
    s_lshr_b32 s52, s52, 18
    s_mul_i32 s53, s52, 5
    s_sub_u32 s53, s51, s53
    s_mul_i32 s52, s52, 40960
    s_lshl_b32 s53, s53, 5
    s_add_u32 s52, s52, s53
    buffer_store_dwordx2 v[190:191], v16, s[36:39], s52 offen
    s_waitcnt vmcnt(8)
    v_lshlrev_b32 v176, 16, v80
    v_and_b32 v177, 4294901760, v80
    v_lshlrev_b32 v178, 16, v81
    v_and_b32 v179, 4294901760, v81
    v_lshlrev_b32 v180, 16, v82
    v_and_b32 v181, 4294901760, v82
    v_lshlrev_b32 v182, 16, v83
    v_and_b32 v183, 4294901760, v83
    v_lshlrev_b32 v4, 16, v84
    v_and_b32 v5, 4294901760, v84
    v_add_f32 v176, v176, v4
    v_add_f32 v177, v177, v5
    v_lshlrev_b32 v4, 16, v85
    v_and_b32 v5, 4294901760, v85
    v_add_f32 v178, v178, v4
    v_add_f32 v179, v179, v5
    v_lshlrev_b32 v4, 16, v86
    v_and_b32 v5, 4294901760, v86
    v_add_f32 v180, v180, v4
    v_add_f32 v181, v181, v5
    v_lshlrev_b32 v4, 16, v87
    v_and_b32 v5, 4294901760, v87
    v_add_f32 v182, v182, v4
    v_add_f32 v183, v183, v5
    v_lshlrev_b32 v4, 16, v88
    v_and_b32 v5, 4294901760, v88
    v_add_f32 v176, v176, v4
    v_add_f32 v177, v177, v5
    v_lshlrev_b32 v4, 16, v89
    v_and_b32 v5, 4294901760, v89
    v_add_f32 v178, v178, v4
    v_add_f32 v179, v179, v5
    v_lshlrev_b32 v4, 16, v90
    v_and_b32 v5, 4294901760, v90
    v_add_f32 v180, v180, v4
    v_add_f32 v181, v181, v5
    v_lshlrev_b32 v4, 16, v91
    v_and_b32 v5, 4294901760, v91
    v_add_f32 v182, v182, v4
    v_add_f32 v183, v183, v5
    v_lshlrev_b32 v4, 16, v92
    v_and_b32 v5, 4294901760, v92
    v_add_f32 v176, v176, v4
    v_add_f32 v177, v177, v5
    v_lshlrev_b32 v4, 16, v93
    v_and_b32 v5, 4294901760, v93
    v_add_f32 v178, v178, v4
    v_add_f32 v179, v179, v5
    v_lshlrev_b32 v4, 16, v94
    v_and_b32 v5, 4294901760, v94
    v_add_f32 v180, v180, v4
    v_add_f32 v181, v181, v5
    v_lshlrev_b32 v4, 16, v95
    v_and_b32 v5, 4294901760, v95
    v_add_f32 v182, v182, v4
    v_add_f32 v183, v183, v5
    v_cvt_pk_bf16_f32 v192, v176, v177
    v_cvt_pk_bf16_f32 v193, v178, v179
    v_cvt_pk_bf16_f32 v194, v180, v181
    v_cvt_pk_bf16_f32 v195, v182, v183
    s_lshl_b32 s51, s48, 1
    s_add_u32 s51, s51, 16
    s_mul_i32 s52, s51, 52429
    s_lshr_b32 s52, s52, 18
    s_mul_i32 s53, s52, 5
    s_sub_u32 s53, s51, s53
    s_mul_i32 s52, s52, 40960
    s_lshl_b32 s53, s53, 5
    s_add_u32 s52, s52, s53
    buffer_store_dwordx2 v[192:193], v16, s[36:39], s52 offen
    s_lshl_b32 s51, s48, 1
    s_add_u32 s51, s51, 17
    s_mul_i32 s52, s51, 52429
    s_lshr_b32 s52, s52, 18
    s_mul_i32 s53, s52, 5
    s_sub_u32 s53, s51, s53
    s_mul_i32 s52, s52, 40960
    s_lshl_b32 s53, s53, 5
    s_add_u32 s52, s52, s53
    buffer_store_dwordx2 v[194:195], v16, s[36:39], s52 offen
    s_cmp_lg_u32 s48, 0
    s_cbranch_scc1 L_FIN
    s_waitcnt vmcnt(6)
    v_lshlrev_b32 v176, 16, v96
    v_and_b32 v177, 4294901760, v96
    v_lshlrev_b32 v178, 16, v97
    v_and_b32 v179, 4294901760, v97
    v_lshlrev_b32 v180, 16, v98
    v_and_b32 v181, 4294901760, v98
    v_lshlrev_b32 v182, 16, v99
    v_and_b32 v183, 4294901760, v99
    v_lshlrev_b32 v4, 16, v100
    v_and_b32 v5, 4294901760, v100
    v_add_f32 v176, v176, v4
    v_add_f32 v177, v177, v5
    v_lshlrev_b32 v4, 16, v101
    v_and_b32 v5, 4294901760, v101
    v_add_f32 v178, v178, v4
    v_add_f32 v179, v179, v5
    v_lshlrev_b32 v4, 16, v102
    v_and_b32 v5, 4294901760, v102
    v_add_f32 v180, v180, v4
    v_add_f32 v181, v181, v5
    v_lshlrev_b32 v4, 16, v103
    v_and_b32 v5, 4294901760, v103
    v_add_f32 v182, v182, v4
    v_add_f32 v183, v183, v5
    v_lshlrev_b32 v4, 16, v104
    v_and_b32 v5, 4294901760, v104
    v_add_f32 v176, v176, v4
    v_add_f32 v177, v177, v5
    v_lshlrev_b32 v4, 16, v105
    v_and_b32 v5, 4294901760, v105
    v_add_f32 v178, v178, v4
    v_add_f32 v179, v179, v5
    v_lshlrev_b32 v4, 16, v106
    v_and_b32 v5, 4294901760, v106
    v_add_f32 v180, v180, v4
    v_add_f32 v181, v181, v5
    v_lshlrev_b32 v4, 16, v107
    v_and_b32 v5, 4294901760, v107
    v_add_f32 v182, v182, v4
    v_add_f32 v183, v183, v5
    v_lshlrev_b32 v4, 16, v108
    v_and_b32 v5, 4294901760, v108
    v_add_f32 v176, v176, v4
    v_add_f32 v177, v177, v5
    v_lshlrev_b32 v4, 16, v109
    v_and_b32 v5, 4294901760, v109
    v_add_f32 v178, v178, v4
    v_add_f32 v179, v179, v5
    v_lshlrev_b32 v4, 16, v110
    v_and_b32 v5, 4294901760, v110
    v_add_f32 v180, v180, v4
    v_add_f32 v181, v181, v5
    v_lshlrev_b32 v4, 16, v111
    v_and_b32 v5, 4294901760, v111
    v_add_f32 v182, v182, v4
    v_add_f32 v183, v183, v5
    v_cvt_pk_bf16_f32 v196, v176, v177
    v_cvt_pk_bf16_f32 v197, v178, v179
    v_cvt_pk_bf16_f32 v198, v180, v181
    v_cvt_pk_bf16_f32 v199, v182, v183
    s_lshl_b32 s51, s48, 1
    s_add_u32 s51, s51, 24
    s_mul_i32 s52, s51, 52429
    s_lshr_b32 s52, s52, 18
    s_mul_i32 s53, s52, 5
    s_sub_u32 s53, s51, s53
    s_mul_i32 s52, s52, 40960
    s_lshl_b32 s53, s53, 5
    s_add_u32 s52, s52, s53
    buffer_store_dwordx2 v[196:197], v16, s[36:39], s52 offen
L_FIN:
L_END:
    s_endpgm
L_EVT:
    s_cmp_eq_u32 s60, 6
    s_cbranch_scc0 L_EVT2
    s_mov_b32 s78, 12
    s_cmp_lg_u32 s48, 3
    s_cbranch_scc1 L_EVTR
    v_mov_b32 v250, 1
    v_mov_b32 v251, 256
    s_mov_b64 exec, 1
    buffer_atomic_add v250, v12, s[40:43], s83 offen sc1
    buffer_atomic_add v251, v12, s[40:43], s63 offen sc1
    s_mov_b64 exec, -1
    s_nop 4
    s_branch L_EVTR
L_EVT2:
    buffer_load_dword v37, v35, s[28:31], s91 offen
    buffer_load_dword v37, v35, s[28:31], s92 offen
    s_branch L_EVTR
L_STUB0:
    s_mov_b32 s72, 0
    s_branch L_SLOW0
L_STUB1:
    s_mov_b32 s72, 1
    s_branch L_SLOW1
L_STUB2:
    s_mov_b32 s72, 2
    s_branch L_SLOW3
L_STUB3:
    s_mov_b32 s72, 3
    s_branch L_SLOW1
L_STUB4:
    s_mov_b32 s72, 4
    s_branch L_SLOW3
L_STUB5:
    s_mov_b32 s72, 5
    s_branch L_SLOW1
L_STUB6:
    s_mov_b32 s72, 6
    s_branch L_SLOW2
L_SLOW0:
    s_nop 15
    v_max3_f32 v240, v48, v49, v50
    v_max3_f32 v241, v51, v52, v53
    v_max3_f32 v240, v54, v55, v240
    v_max_f32 v240, v240, v241
    v_mov_b32 v241, v240
    s_nop 1
    v_permlane32_swap_b32 v240, v241
    v_max_f32 v240, v240, v241
    v_mov_b32 v241, v240
    s_nop 1
    v_permlane16_swap_b32 v240, v241
    v_max_f32 v240, v240, v241
    v_add_f32 v240, 1092616192, v240
    v_max_f32 v240, 0, v240
    v_sub_f32 v242, 0, v240
    v_exp_f32 v242, v242
    v_sub_f32 v48, v48, v240
    v_sub_f32 v49, v49, v240
    v_sub_f32 v50, v50, v240
    v_sub_f32 v51, v51, v240
    v_sub_f32 v52, v52, v240
    v_sub_f32 v53, v53, v240
    v_sub_f32 v54, v54, v240
    v_sub_f32 v55, v55, v240
    v_sub_f32 v108, v108, v240
    v_sub_f32 v109, v109, v240
    v_sub_f32 v110, v110, v240
    v_sub_f32 v111, v111, v240
    v_mul_f32 v128, v242, v128
    v_mul_f32 v129, v242, v129
    v_mul_f32 v130, v242, v130
    v_mul_f32 v131, v242, v131
    v_accvgpr_read_b32 v243, a0
    v_mul_f32 v243, v242, v243
    v_accvgpr_write_b32 a0, v243
    v_accvgpr_read_b32 v243, a1
    v_mul_f32 v243, v242, v243
    v_accvgpr_write_b32 a1, v243
    v_accvgpr_read_b32 v243, a2
    v_mul_f32 v243, v242, v243
    v_accvgpr_write_b32 a2, v243
    v_accvgpr_read_b32 v243, a3
    v_mul_f32 v243, v242, v243
    v_accvgpr_write_b32 a3, v243
    v_accvgpr_read_b32 v243, a4
    v_mul_f32 v243, v242, v243
    v_accvgpr_write_b32 a4, v243
    v_accvgpr_read_b32 v243, a5
    v_mul_f32 v243, v242, v243
    v_accvgpr_write_b32 a5, v243
    v_accvgpr_read_b32 v243, a6
    v_mul_f32 v243, v242, v243
    v_accvgpr_write_b32 a6, v243
    v_accvgpr_read_b32 v243, a7
    v_mul_f32 v243, v242, v243
    v_accvgpr_write_b32 a7, v243
    v_accvgpr_read_b32 v243, a8
    v_mul_f32 v243, v242, v243
    v_accvgpr_write_b32 a8, v243
    v_accvgpr_read_b32 v243, a9
    v_mul_f32 v243, v242, v243
    v_accvgpr_write_b32 a9, v243
    v_accvgpr_read_b32 v243, a10
    v_mul_f32 v243, v242, v243
    v_accvgpr_write_b32 a10, v243
    v_accvgpr_read_b32 v243, a11
    v_mul_f32 v243, v242, v243
    v_accvgpr_write_b32 a11, v243
    v_accvgpr_read_b32 v243, a12
    v_mul_f32 v243, v242, v243
    v_accvgpr_write_b32 a12, v243
    v_accvgpr_read_b32 v243, a13
    v_mul_f32 v243, v242, v243
    v_accvgpr_write_b32 a13, v243
    v_accvgpr_read_b32 v243, a14
    v_mul_f32 v243, v242, v243
    v_accvgpr_write_b32 a14, v243
    v_accvgpr_read_b32 v243, a15
    v_mul_f32 v243, v242, v243
    v_accvgpr_write_b32 a15, v243
    v_accvgpr_read_b32 v243, a16
    v_mul_f32 v243, v242, v243
    v_accvgpr_write_b32 a16, v243
    v_accvgpr_read_b32 v243, a17
    v_mul_f32 v243, v242, v243
    v_accvgpr_write_b32 a17, v243
    v_accvgpr_read_b32 v243, a18
    v_mul_f32 v243, v242, v243
    v_accvgpr_write_b32 a18, v243
    v_accvgpr_read_b32 v243, a19
    v_mul_f32 v243, v242, v243
    v_accvgpr_write_b32 a19, v243
    v_accvgpr_read_b32 v243, a20
    v_mul_f32 v243, v242, v243
    v_accvgpr_write_b32 a20, v243
    v_accvgpr_read_b32 v243, a21
    v_mul_f32 v243, v242, v243
    v_accvgpr_write_b32 a21, v243
    v_accvgpr_read_b32 v243, a22
    v_mul_f32 v243, v242, v243
    v_accvgpr_write_b32 a22, v243
    v_accvgpr_read_b32 v243, a23
    v_mul_f32 v243, v242, v243
    v_accvgpr_write_b32 a23, v243
    v_accvgpr_read_b32 v243, a24
    v_mul_f32 v243, v242, v243
    v_accvgpr_write_b32 a24, v243
    v_accvgpr_read_b32 v243, a25
    v_mul_f32 v243, v242, v243
    v_accvgpr_write_b32 a25, v243
    v_accvgpr_read_b32 v243, a26
    v_mul_f32 v243, v242, v243
    v_accvgpr_write_b32 a26, v243
    v_accvgpr_read_b32 v243, a27
    v_mul_f32 v243, v242, v243
    v_accvgpr_write_b32 a27, v243
    v_accvgpr_read_b32 v243, a28
    v_mul_f32 v243, v242, v243
    v_accvgpr_write_b32 a28, v243
    v_accvgpr_read_b32 v243, a29
    v_mul_f32 v243, v242, v243
    v_accvgpr_write_b32 a29, v243
    v_accvgpr_read_b32 v243, a30
    v_mul_f32 v243, v242, v243
    v_accvgpr_write_b32 a30, v243
    v_accvgpr_read_b32 v243, a31
    v_mul_f32 v243, v242, v243
    v_accvgpr_write_b32 a31, v243
    v_exp_f32 v241, v48
    v_exp_f32 v243, v49
    s_nop 0
    v_cvt_pk_bf16_f32 v88, v241, v243
    v_exp_f32 v241, v50
    v_exp_f32 v243, v51
    s_nop 0
    v_cvt_pk_bf16_f32 v89, v241, v243
    v_exp_f32 v241, v52
    v_exp_f32 v243, v53
    s_nop 0
    v_cvt_pk_bf16_f32 v90, v241, v243
    v_exp_f32 v241, v54
    v_exp_f32 v243, v55
    s_nop 0
    v_cvt_pk_bf16_f32 v91, v241, v243
    s_nop 3
    s_branch L_RET0
L_SLOW1:
    s_nop 15
    v_max3_f32 v240, v56, v57, v58
    v_max3_f32 v241, v59, v60, v61
    v_max3_f32 v240, v62, v63, v240
    v_max_f32 v240, v240, v241
    v_mov_b32 v241, v240
    s_nop 1
    v_permlane32_swap_b32 v240, v241
    v_max_f32 v240, v240, v241
    v_mov_b32 v241, v240
    s_nop 1
    v_permlane16_swap_b32 v240, v241
    v_max_f32 v240, v240, v241
    v_add_f32 v240, 1092616192, v240
    v_max_f32 v240, 0, v240
    v_sub_f32 v242, 0, v240
    v_exp_f32 v242, v242
    v_sub_f32 v56, v56, v240
    v_sub_f32 v57, v57, v240
    v_sub_f32 v58, v58, v240
    v_sub_f32 v59, v59, v240
    v_sub_f32 v60, v60, v240
    v_sub_f32 v61, v61, v240
    v_sub_f32 v62, v62, v240
    v_sub_f32 v63, v63, v240
    v_sub_f32 v112, v112, v240
    v_sub_f32 v113, v113, v240
    v_sub_f32 v114, v114, v240
    v_sub_f32 v115, v115, v240
    v_mul_f32 v132, v242, v132
    v_mul_f32 v133, v242, v133
    v_mul_f32 v134, v242, v134
    v_mul_f32 v135, v242, v135
    v_accvgpr_read_b32 v243, a32
    v_mul_f32 v243, v242, v243
    v_accvgpr_write_b32 a32, v243
    v_accvgpr_read_b32 v243, a33
    v_mul_f32 v243, v242, v243
    v_accvgpr_write_b32 a33, v243
    v_accvgpr_read_b32 v243, a34
    v_mul_f32 v243, v242, v243
    v_accvgpr_write_b32 a34, v243
    v_accvgpr_read_b32 v243, a35
    v_mul_f32 v243, v242, v243
    v_accvgpr_write_b32 a35, v243
    v_accvgpr_read_b32 v243, a36
    v_mul_f32 v243, v242, v243
    v_accvgpr_write_b32 a36, v243
    v_accvgpr_read_b32 v243, a37
    v_mul_f32 v243, v242, v243
    v_accvgpr_write_b32 a37, v243
    v_accvgpr_read_b32 v243, a38
    v_mul_f32 v243, v242, v243
    v_accvgpr_write_b32 a38, v243
    v_accvgpr_read_b32 v243, a39
    v_mul_f32 v243, v242, v243
    v_accvgpr_write_b32 a39, v243
    v_accvgpr_read_b32 v243, a40
    v_mul_f32 v243, v242, v243
    v_accvgpr_write_b32 a40, v243
    v_accvgpr_read_b32 v243, a41
    v_mul_f32 v243, v242, v243
    v_accvgpr_write_b32 a41, v243
    v_accvgpr_read_b32 v243, a42
    v_mul_f32 v243, v242, v243
    v_accvgpr_write_b32 a42, v243
    v_accvgpr_read_b32 v243, a43
    v_mul_f32 v243, v242, v243
    v_accvgpr_write_b32 a43, v243
    v_accvgpr_read_b32 v243, a44
    v_mul_f32 v243, v242, v243
    v_accvgpr_write_b32 a44, v243
    v_accvgpr_read_b32 v243, a45
    v_mul_f32 v243, v242, v243
    v_accvgpr_write_b32 a45, v243
    v_accvgpr_read_b32 v243, a46
    v_mul_f32 v243, v242, v243
    v_accvgpr_write_b32 a46, v243
    v_accvgpr_read_b32 v243, a47
    v_mul_f32 v243, v242, v243
    v_accvgpr_write_b32 a47, v243
    v_accvgpr_read_b32 v243, a48
    v_mul_f32 v243, v242, v243
    v_accvgpr_write_b32 a48, v243
    v_accvgpr_read_b32 v243, a49
    v_mul_f32 v243, v242, v243
    v_accvgpr_write_b32 a49, v243
    v_accvgpr_read_b32 v243, a50
    v_mul_f32 v243, v242, v243
    v_accvgpr_write_b32 a50, v243
    v_accvgpr_read_b32 v243, a51
    v_mul_f32 v243, v242, v243
    v_accvgpr_write_b32 a51, v243
    v_accvgpr_read_b32 v243, a52
    v_mul_f32 v243, v242, v243
    v_accvgpr_write_b32 a52, v243
    v_accvgpr_read_b32 v243, a53
    v_mul_f32 v243, v242, v243
    v_accvgpr_write_b32 a53, v243
    v_accvgpr_read_b32 v243, a54
    v_mul_f32 v243, v242, v243
    v_accvgpr_write_b32 a54, v243
    v_accvgpr_read_b32 v243, a55
    v_mul_f32 v243, v242, v243
    v_accvgpr_write_b32 a55, v243
    v_accvgpr_read_b32 v243, a56
    v_mul_f32 v243, v242, v243
    v_accvgpr_write_b32 a56, v243
    v_accvgpr_read_b32 v243, a57
    v_mul_f32 v243, v242, v243
    v_accvgpr_write_b32 a57, v243
    v_accvgpr_read_b32 v243, a58
    v_mul_f32 v243, v242, v243
    v_accvgpr_write_b32 a58, v243
    v_accvgpr_read_b32 v243, a59
    v_mul_f32 v243, v242, v243
    v_accvgpr_write_b32 a59, v243
    v_accvgpr_read_b32 v243, a60
    v_mul_f32 v243, v242, v243
    v_accvgpr_write_b32 a60, v243
    v_accvgpr_read_b32 v243, a61
    v_mul_f32 v243, v242, v243
    v_accvgpr_write_b32 a61, v243
    v_accvgpr_read_b32 v243, a62
    v_mul_f32 v243, v242, v243
    v_accvgpr_write_b32 a62, v243
    v_accvgpr_read_b32 v243, a63
    v_mul_f32 v243, v242, v243
    v_accvgpr_write_b32 a63, v243
    v_exp_f32 v241, v56
    v_exp_f32 v243, v57
    s_nop 0
    v_cvt_pk_bf16_f32 v92, v241, v243
    v_exp_f32 v241, v58
    v_exp_f32 v243, v59
    s_nop 0
    v_cvt_pk_bf16_f32 v93, v241, v243
    v_exp_f32 v241, v60
    v_exp_f32 v243, v61
    s_nop 0
    v_cvt_pk_bf16_f32 v94, v241, v243
    v_exp_f32 v241, v62
    v_exp_f32 v243, v63
    s_nop 0
    v_cvt_pk_bf16_f32 v95, v241, v243
    v_max3_f32 v240, v64, v65, v66
    v_max3_f32 v241, v67, v68, v69
    v_max3_f32 v240, v70, v71, v240
    v_max_f32 v240, v240, v241
    v_mov_b32 v241, v240
    s_nop 1
    v_permlane32_swap_b32 v240, v241
    v_max_f32 v240, v240, v241
    v_mov_b32 v241, v240
    s_nop 1
    v_permlane16_swap_b32 v240, v241
    v_max_f32 v240, v240, v241
    v_add_f32 v240, 1092616192, v240
    v_max_f32 v240, 0, v240
    v_sub_f32 v242, 0, v240
    v_exp_f32 v242, v242
    v_sub_f32 v64, v64, v240
    v_sub_f32 v65, v65, v240
    v_sub_f32 v66, v66, v240
    v_sub_f32 v67, v67, v240
    v_sub_f32 v68, v68, v240
    v_sub_f32 v69, v69, v240
    v_sub_f32 v70, v70, v240
    v_sub_f32 v71, v71, v240
    v_sub_f32 v116, v116, v240
    v_sub_f32 v117, v117, v240
    v_sub_f32 v118, v118, v240
    v_sub_f32 v119, v119, v240
    v_mul_f32 v136, v242, v136
    v_mul_f32 v137, v242, v137
    v_mul_f32 v138, v242, v138
    v_mul_f32 v139, v242, v139
    v_accvgpr_read_b32 v243, a64
    v_mul_f32 v243, v242, v243
    v_accvgpr_write_b32 a64, v243
    v_accvgpr_read_b32 v243, a65
    v_mul_f32 v243, v242, v243
    v_accvgpr_write_b32 a65, v243
    v_accvgpr_read_b32 v243, a66
    v_mul_f32 v243, v242, v243
    v_accvgpr_write_b32 a66, v243
    v_accvgpr_read_b32 v243, a67
    v_mul_f32 v243, v242, v243
    v_accvgpr_write_b32 a67, v243
    v_accvgpr_read_b32 v243, a68
    v_mul_f32 v243, v242, v243
    v_accvgpr_write_b32 a68, v243
    v_accvgpr_read_b32 v243, a69
    v_mul_f32 v243, v242, v243
    v_accvgpr_write_b32 a69, v243
    v_accvgpr_read_b32 v243, a70
    v_mul_f32 v243, v242, v243
    v_accvgpr_write_b32 a70, v243
    v_accvgpr_read_b32 v243, a71
    v_mul_f32 v243, v242, v243
    v_accvgpr_write_b32 a71, v243
    v_accvgpr_read_b32 v243, a72
    v_mul_f32 v243, v242, v243
    v_accvgpr_write_b32 a72, v243
    v_accvgpr_read_b32 v243, a73
    v_mul_f32 v243, v242, v243
    v_accvgpr_write_b32 a73, v243
    v_accvgpr_read_b32 v243, a74
    v_mul_f32 v243, v242, v243
    v_accvgpr_write_b32 a74, v243
    v_accvgpr_read_b32 v243, a75
    v_mul_f32 v243, v242, v243
    v_accvgpr_write_b32 a75, v243
    v_accvgpr_read_b32 v243, a76
    v_mul_f32 v243, v242, v243
    v_accvgpr_write_b32 a76, v243
    v_accvgpr_read_b32 v243, a77
    v_mul_f32 v243, v242, v243
    v_accvgpr_write_b32 a77, v243
    v_accvgpr_read_b32 v243, a78
    v_mul_f32 v243, v242, v243
    v_accvgpr_write_b32 a78, v243
    v_accvgpr_read_b32 v243, a79
    v_mul_f32 v243, v242, v243
    v_accvgpr_write_b32 a79, v243
    v_accvgpr_read_b32 v243, a80
    v_mul_f32 v243, v242, v243
    v_accvgpr_write_b32 a80, v243
    v_accvgpr_read_b32 v243, a81
    v_mul_f32 v243, v242, v243
    v_accvgpr_write_b32 a81, v243
    v_accvgpr_read_b32 v243, a82
    v_mul_f32 v243, v242, v243
    v_accvgpr_write_b32 a82, v243
    v_accvgpr_read_b32 v243, a83
    v_mul_f32 v243, v242, v243
    v_accvgpr_write_b32 a83, v243
    v_accvgpr_read_b32 v243, a84
    v_mul_f32 v243, v242, v243
    v_accvgpr_write_b32 a84, v243
    v_accvgpr_read_b32 v243, a85
    v_mul_f32 v243, v242, v243
    v_accvgpr_write_b32 a85, v243
    v_accvgpr_read_b32 v243, a86
    v_mul_f32 v243, v242, v243
    v_accvgpr_write_b32 a86, v243
    v_accvgpr_read_b32 v243, a87
    v_mul_f32 v243, v242, v243
    v_accvgpr_write_b32 a87, v243
    v_accvgpr_read_b32 v243, a88
    v_mul_f32 v243, v242, v243
    v_accvgpr_write_b32 a88, v243
    v_accvgpr_read_b32 v243, a89
    v_mul_f32 v243, v242, v243
    v_accvgpr_write_b32 a89, v243
    v_accvgpr_read_b32 v243, a90
    v_mul_f32 v243, v242, v243
    v_accvgpr_write_b32 a90, v243
    v_accvgpr_read_b32 v243, a91
    v_mul_f32 v243, v242, v243
    v_accvgpr_write_b32 a91, v243
    v_accvgpr_read_b32 v243, a92
    v_mul_f32 v243, v242, v243
    v_accvgpr_write_b32 a92, v243
    v_accvgpr_read_b32 v243, a93
    v_mul_f32 v243, v242, v243
    v_accvgpr_write_b32 a93, v243
    v_accvgpr_read_b32 v243, a94
    v_mul_f32 v243, v242, v243
    v_accvgpr_write_b32 a94, v243
    v_accvgpr_read_b32 v243, a95
    v_mul_f32 v243, v242, v243
    v_accvgpr_write_b32 a95, v243
    v_exp_f32 v241, v64
    v_exp_f32 v243, v65
    s_nop 0
    v_cvt_pk_bf16_f32 v96, v241, v243
    v_exp_f32 v241, v66
    v_exp_f32 v243, v67
    s_nop 0
    v_cvt_pk_bf16_f32 v97, v241, v243
    v_exp_f32 v241, v68
    v_exp_f32 v243, v69
    s_nop 0
    v_cvt_pk_bf16_f32 v98, v241, v243
    v_exp_f32 v241, v70
    v_exp_f32 v243, v71
    s_nop 0
    v_cvt_pk_bf16_f32 v99, v241, v243
    s_nop 3
    s_cmp_eq_u32 s72, 1
    s_cbranch_scc1 L_RET1
    s_cmp_eq_u32 s72, 3
    s_cbranch_scc1 L_RET3
    s_branch L_RET5
L_SLOW2:
    s_nop 15
    v_max3_f32 v240, v72, v73, v74
    v_max3_f32 v241, v75, v76, v77
    v_max3_f32 v240, v78, v79, v240
    v_max_f32 v240, v240, v241
    v_mov_b32 v241, v240
    s_nop 1
    v_permlane32_swap_b32 v240, v241
    v_max_f32 v240, v240, v241
    v_mov_b32 v241, v240
    s_nop 1
    v_permlane16_swap_b32 v240, v241
    v_max_f32 v240, v240, v241
    v_add_f32 v240, 1092616192, v240
    v_max_f32 v240, 0, v240
    v_sub_f32 v242, 0, v240
    v_exp_f32 v242, v242
    v_sub_f32 v72, v72, v240
    v_sub_f32 v73, v73, v240
    v_sub_f32 v74, v74, v240
    v_sub_f32 v75, v75, v240
    v_sub_f32 v76, v76, v240
    v_sub_f32 v77, v77, v240
    v_sub_f32 v78, v78, v240
    v_sub_f32 v79, v79, v240
    v_sub_f32 v120, v120, v240
    v_sub_f32 v121, v121, v240
    v_sub_f32 v122, v122, v240
    v_sub_f32 v123, v123, v240
    v_mul_f32 v140, v242, v140
    v_mul_f32 v141, v242, v141
    v_mul_f32 v142, v242, v142
    v_mul_f32 v143, v242, v143
    v_accvgpr_read_b32 v243, a96
    v_mul_f32 v243, v242, v243
    v_accvgpr_write_b32 a96, v243
    v_accvgpr_read_b32 v243, a97
    v_mul_f32 v243, v242, v243
    v_accvgpr_write_b32 a97, v243
    v_accvgpr_read_b32 v243, a98
    v_mul_f32 v243, v242, v243
    v_accvgpr_write_b32 a98, v243
    v_accvgpr_read_b32 v243, a99
    v_mul_f32 v243, v242, v243
    v_accvgpr_write_b32 a99, v243
    v_accvgpr_read_b32 v243, a100
    v_mul_f32 v243, v242, v243
    v_accvgpr_write_b32 a100, v243
    v_accvgpr_read_b32 v243, a101
    v_mul_f32 v243, v242, v243
    v_accvgpr_write_b32 a101, v243
    v_accvgpr_read_b32 v243, a102
    v_mul_f32 v243, v242, v243
    v_accvgpr_write_b32 a102, v243
    v_accvgpr_read_b32 v243, a103
    v_mul_f32 v243, v242, v243
    v_accvgpr_write_b32 a103, v243
    v_accvgpr_read_b32 v243, a104
    v_mul_f32 v243, v242, v243
    v_accvgpr_write_b32 a104, v243
    v_accvgpr_read_b32 v243, a105
    v_mul_f32 v243, v242, v243
    v_accvgpr_write_b32 a105, v243
    v_accvgpr_read_b32 v243, a106
    v_mul_f32 v243, v242, v243
    v_accvgpr_write_b32 a106, v243
    v_accvgpr_read_b32 v243, a107
    v_mul_f32 v243, v242, v243
    v_accvgpr_write_b32 a107, v243
    v_accvgpr_read_b32 v243, a108
    v_mul_f32 v243, v242, v243
    v_accvgpr_write_b32 a108, v243
    v_accvgpr_read_b32 v243, a109
    v_mul_f32 v243, v242, v243
    v_accvgpr_write_b32 a109, v243
    v_accvgpr_read_b32 v243, a110
    v_mul_f32 v243, v242, v243
    v_accvgpr_write_b32 a110, v243
    v_accvgpr_read_b32 v243, a111
    v_mul_f32 v243, v242, v243
    v_accvgpr_write_b32 a111, v243
    v_accvgpr_read_b32 v243, a112
    v_mul_f32 v243, v242, v243
    v_accvgpr_write_b32 a112, v243
    v_accvgpr_read_b32 v243, a113
    v_mul_f32 v243, v242, v243
    v_accvgpr_write_b32 a113, v243
    v_accvgpr_read_b32 v243, a114
    v_mul_f32 v243, v242, v243
    v_accvgpr_write_b32 a114, v243
    v_accvgpr_read_b32 v243, a115
    v_mul_f32 v243, v242, v243
    v_accvgpr_write_b32 a115, v243
    v_accvgpr_read_b32 v243, a116
    v_mul_f32 v243, v242, v243
    v_accvgpr_write_b32 a116, v243
    v_accvgpr_read_b32 v243, a117
    v_mul_f32 v243, v242, v243
    v_accvgpr_write_b32 a117, v243
    v_accvgpr_read_b32 v243, a118
    v_mul_f32 v243, v242, v243
    v_accvgpr_write_b32 a118, v243
    v_accvgpr_read_b32 v243, a119
    v_mul_f32 v243, v242, v243
    v_accvgpr_write_b32 a119, v243
    v_accvgpr_read_b32 v243, a120
    v_mul_f32 v243, v242, v243
    v_accvgpr_write_b32 a120, v243
    v_accvgpr_read_b32 v243, a121
    v_mul_f32 v243, v242, v243
    v_accvgpr_write_b32 a121, v243
    v_accvgpr_read_b32 v243, a122
    v_mul_f32 v243, v242, v243
    v_accvgpr_write_b32 a122, v243
    v_accvgpr_read_b32 v243, a123
    v_mul_f32 v243, v242, v243
    v_accvgpr_write_b32 a123, v243
    v_accvgpr_read_b32 v243, a124
    v_mul_f32 v243, v242, v243
    v_accvgpr_write_b32 a124, v243
    v_accvgpr_read_b32 v243, a125
    v_mul_f32 v243, v242, v243
    v_accvgpr_write_b32 a125, v243
    v_accvgpr_read_b32 v243, a126
    v_mul_f32 v243, v242, v243
    v_accvgpr_write_b32 a126, v243
    v_accvgpr_read_b32 v243, a127
    v_mul_f32 v243, v242, v243
    v_accvgpr_write_b32 a127, v243
    v_exp_f32 v241, v72
    v_exp_f32 v243, v73
    s_nop 0
    v_cvt_pk_bf16_f32 v100, v241, v243
    v_exp_f32 v241, v74
    v_exp_f32 v243, v75
    s_nop 0
    v_cvt_pk_bf16_f32 v101, v241, v243
    v_exp_f32 v241, v76
    v_exp_f32 v243, v77
    s_nop 0
    v_cvt_pk_bf16_f32 v102, v241, v243
    v_exp_f32 v241, v78
    v_exp_f32 v243, v79
    s_nop 0
    v_cvt_pk_bf16_f32 v103, v241, v243
    v_max3_f32 v240, v80, v81, v82
    v_max3_f32 v241, v83, v84, v85
    v_max3_f32 v240, v86, v87, v240
    v_max_f32 v240, v240, v241
    v_mov_b32 v241, v240
    s_nop 1
    v_permlane32_swap_b32 v240, v241
    v_max_f32 v240, v240, v241
    v_mov_b32 v241, v240
    s_nop 1
    v_permlane16_swap_b32 v240, v241
    v_max_f32 v240, v240, v241
    v_add_f32 v240, 1092616192, v240
    v_max_f32 v240, 0, v240
    v_sub_f32 v242, 0, v240
    v_exp_f32 v242, v242
    v_sub_f32 v80, v80, v240
    v_sub_f32 v81, v81, v240
    v_sub_f32 v82, v82, v240
    v_sub_f32 v83, v83, v240
    v_sub_f32 v84, v84, v240
    v_sub_f32 v85, v85, v240
    v_sub_f32 v86, v86, v240
    v_sub_f32 v87, v87, v240
    v_sub_f32 v124, v124, v240
    v_sub_f32 v125, v125, v240
    v_sub_f32 v126, v126, v240
    v_sub_f32 v127, v127, v240
    v_mul_f32 v144, v242, v144
    v_mul_f32 v145, v242, v145
    v_mul_f32 v146, v242, v146
    v_mul_f32 v147, v242, v147
    v_accvgpr_read_b32 v243, a128
    v_mul_f32 v243, v242, v243
    v_accvgpr_write_b32 a128, v243
    v_accvgpr_read_b32 v243, a129
    v_mul_f32 v243, v242, v243
    v_accvgpr_write_b32 a129, v243
    v_accvgpr_read_b32 v243, a130
    v_mul_f32 v243, v242, v243
    v_accvgpr_write_b32 a130, v243
    v_accvgpr_read_b32 v243, a131
    v_mul_f32 v243, v242, v243
    v_accvgpr_write_b32 a131, v243
    v_accvgpr_read_b32 v243, a132
    v_mul_f32 v243, v242, v243
    v_accvgpr_write_b32 a132, v243
    v_accvgpr_read_b32 v243, a133
    v_mul_f32 v243, v242, v243
    v_accvgpr_write_b32 a133, v243
    v_accvgpr_read_b32 v243, a134
    v_mul_f32 v243, v242, v243
    v_accvgpr_write_b32 a134, v243
    v_accvgpr_read_b32 v243, a135
    v_mul_f32 v243, v242, v243
    v_accvgpr_write_b32 a135, v243
    v_accvgpr_read_b32 v243, a136
    v_mul_f32 v243, v242, v243
    v_accvgpr_write_b32 a136, v243
    v_accvgpr_read_b32 v243, a137
    v_mul_f32 v243, v242, v243
    v_accvgpr_write_b32 a137, v243
    v_accvgpr_read_b32 v243, a138
    v_mul_f32 v243, v242, v243
    v_accvgpr_write_b32 a138, v243
    v_accvgpr_read_b32 v243, a139
    v_mul_f32 v243, v242, v243
    v_accvgpr_write_b32 a139, v243
    v_accvgpr_read_b32 v243, a140
    v_mul_f32 v243, v242, v243
    v_accvgpr_write_b32 a140, v243
    v_accvgpr_read_b32 v243, a141
    v_mul_f32 v243, v242, v243
    v_accvgpr_write_b32 a141, v243
    v_accvgpr_read_b32 v243, a142
    v_mul_f32 v243, v242, v243
    v_accvgpr_write_b32 a142, v243
    v_accvgpr_read_b32 v243, a143
    v_mul_f32 v243, v242, v243
    v_accvgpr_write_b32 a143, v243
    v_accvgpr_read_b32 v243, a144
    v_mul_f32 v243, v242, v243
    v_accvgpr_write_b32 a144, v243
    v_accvgpr_read_b32 v243, a145
    v_mul_f32 v243, v242, v243
    v_accvgpr_write_b32 a145, v243
    v_accvgpr_read_b32 v243, a146
    v_mul_f32 v243, v242, v243
    v_accvgpr_write_b32 a146, v243
    v_accvgpr_read_b32 v243, a147
    v_mul_f32 v243, v242, v243
    v_accvgpr_write_b32 a147, v243
    v_accvgpr_read_b32 v243, a148
    v_mul_f32 v243, v242, v243
    v_accvgpr_write_b32 a148, v243
    v_accvgpr_read_b32 v243, a149
    v_mul_f32 v243, v242, v243
    v_accvgpr_write_b32 a149, v243
    v_accvgpr_read_b32 v243, a150
    v_mul_f32 v243, v242, v243
    v_accvgpr_write_b32 a150, v243
    v_accvgpr_read_b32 v243, a151
    v_mul_f32 v243, v242, v243
    v_accvgpr_write_b32 a151, v243
    v_accvgpr_read_b32 v243, a152
    v_mul_f32 v243, v242, v243
    v_accvgpr_write_b32 a152, v243
    v_accvgpr_read_b32 v243, a153
    v_mul_f32 v243, v242, v243
    v_accvgpr_write_b32 a153, v243
    v_accvgpr_read_b32 v243, a154
    v_mul_f32 v243, v242, v243
    v_accvgpr_write_b32 a154, v243
    v_accvgpr_read_b32 v243, a155
    v_mul_f32 v243, v242, v243
    v_accvgpr_write_b32 a155, v243
    v_accvgpr_read_b32 v243, a156
    v_mul_f32 v243, v242, v243
    v_accvgpr_write_b32 a156, v243
    v_accvgpr_read_b32 v243, a157
    v_mul_f32 v243, v242, v243
    v_accvgpr_write_b32 a157, v243
    v_accvgpr_read_b32 v243, a158
    v_mul_f32 v243, v242, v243
    v_accvgpr_write_b32 a158, v243
    v_accvgpr_read_b32 v243, a159
    v_mul_f32 v243, v242, v243
    v_accvgpr_write_b32 a159, v243
    v_exp_f32 v241, v80
    v_exp_f32 v243, v81
    s_nop 0
    v_cvt_pk_bf16_f32 v104, v241, v243
    v_exp_f32 v241, v82
    v_exp_f32 v243, v83
    s_nop 0
    v_cvt_pk_bf16_f32 v105, v241, v243
    v_exp_f32 v241, v84
    v_exp_f32 v243, v85
    s_nop 0
    v_cvt_pk_bf16_f32 v106, v241, v243
    v_exp_f32 v241, v86
    v_exp_f32 v243, v87
    s_nop 0
    v_cvt_pk_bf16_f32 v107, v241, v243
    s_nop 3
    s_branch L_RET6
L_SLOW3:
    s_nop 15
    v_max3_f32 v240, v72, v73, v74
    v_max3_f32 v241, v75, v76, v77
    v_max3_f32 v240, v78, v79, v240
    v_max_f32 v240, v240, v241
    v_mov_b32 v241, v240
    s_nop 1
    v_permlane32_swap_b32 v240, v241
    v_max_f32 v240, v240, v241
    v_mov_b32 v241, v240
    s_nop 1
    v_permlane16_swap_b32 v240, v241
    v_max_f32 v240, v240, v241
    v_add_f32 v240, 1092616192, v240
    v_max_f32 v240, 0, v240
    v_sub_f32 v242, 0, v240
    v_exp_f32 v242, v242
    v_sub_f32 v72, v72, v240
    v_sub_f32 v73, v73, v240
    v_sub_f32 v74, v74, v240
    v_sub_f32 v75, v75, v240
    v_sub_f32 v76, v76, v240
    v_sub_f32 v77, v77, v240
    v_sub_f32 v78, v78, v240
    v_sub_f32 v79, v79, v240
    v_sub_f32 v120, v120, v240
    v_sub_f32 v121, v121, v240
    v_sub_f32 v122, v122, v240
    v_sub_f32 v123, v123, v240
    v_mul_f32 v140, v242, v140
    v_mul_f32 v141, v242, v141
    v_mul_f32 v142, v242, v142
    v_mul_f32 v143, v242, v143
    v_accvgpr_read_b32 v243, a96
    v_mul_f32 v243, v242, v243
    v_accvgpr_write_b32 a96, v243
    v_accvgpr_read_b32 v243, a97
    v_mul_f32 v243, v242, v243
    v_accvgpr_write_b32 a97, v243
    v_accvgpr_read_b32 v243, a98
    v_mul_f32 v243, v242, v243
    v_accvgpr_write_b32 a98, v243
    v_accvgpr_read_b32 v243, a99
    v_mul_f32 v243, v242, v243
    v_accvgpr_write_b32 a99, v243
    v_accvgpr_read_b32 v243, a100
    v_mul_f32 v243, v242, v243
    v_accvgpr_write_b32 a100, v243
    v_accvgpr_read_b32 v243, a101
    v_mul_f32 v243, v242, v243
    v_accvgpr_write_b32 a101, v243
    v_accvgpr_read_b32 v243, a102
    v_mul_f32 v243, v242, v243
    v_accvgpr_write_b32 a102, v243
    v_accvgpr_read_b32 v243, a103
    v_mul_f32 v243, v242, v243
    v_accvgpr_write_b32 a103, v243
    v_accvgpr_read_b32 v243, a104
    v_mul_f32 v243, v242, v243
    v_accvgpr_write_b32 a104, v243
    v_accvgpr_read_b32 v243, a105
    v_mul_f32 v243, v242, v243
    v_accvgpr_write_b32 a105, v243
    v_accvgpr_read_b32 v243, a106
    v_mul_f32 v243, v242, v243
    v_accvgpr_write_b32 a106, v243
    v_accvgpr_read_b32 v243, a107
    v_mul_f32 v243, v242, v243
    v_accvgpr_write_b32 a107, v243
    v_accvgpr_read_b32 v243, a108
    v_mul_f32 v243, v242, v243
    v_accvgpr_write_b32 a108, v243
    v_accvgpr_read_b32 v243, a109
    v_mul_f32 v243, v242, v243
    v_accvgpr_write_b32 a109, v243
    v_accvgpr_read_b32 v243, a110
    v_mul_f32 v243, v242, v243
    v_accvgpr_write_b32 a110, v243
    v_accvgpr_read_b32 v243, a111
    v_mul_f32 v243, v242, v243
    v_accvgpr_write_b32 a111, v243
    v_accvgpr_read_b32 v243, a112
    v_mul_f32 v243, v242, v243
    v_accvgpr_write_b32 a112, v243
    v_accvgpr_read_b32 v243, a113
    v_mul_f32 v243, v242, v243
    v_accvgpr_write_b32 a113, v243
    v_accvgpr_read_b32 v243, a114
    v_mul_f32 v243, v242, v243
    v_accvgpr_write_b32 a114, v243
    v_accvgpr_read_b32 v243, a115
    v_mul_f32 v243, v242, v243
    v_accvgpr_write_b32 a115, v243
    v_accvgpr_read_b32 v243, a116
    v_mul_f32 v243, v242, v243
    v_accvgpr_write_b32 a116, v243
    v_accvgpr_read_b32 v243, a117
    v_mul_f32 v243, v242, v243
    v_accvgpr_write_b32 a117, v243
    v_accvgpr_read_b32 v243, a118
    v_mul_f32 v243, v242, v243
    v_accvgpr_write_b32 a118, v243
    v_accvgpr_read_b32 v243, a119
    v_mul_f32 v243, v242, v243
    v_accvgpr_write_b32 a119, v243
    v_accvgpr_read_b32 v243, a120
    v_mul_f32 v243, v242, v243
    v_accvgpr_write_b32 a120, v243
    v_accvgpr_read_b32 v243, a121
    v_mul_f32 v243, v242, v243
    v_accvgpr_write_b32 a121, v243
    v_accvgpr_read_b32 v243, a122
    v_mul_f32 v243, v242, v243
    v_accvgpr_write_b32 a122, v243
    v_accvgpr_read_b32 v243, a123
    v_mul_f32 v243, v242, v243
    v_accvgpr_write_b32 a123, v243
    v_accvgpr_read_b32 v243, a124
    v_mul_f32 v243, v242, v243
    v_accvgpr_write_b32 a124, v243
    v_accvgpr_read_b32 v243, a125
    v_mul_f32 v243, v242, v243
    v_accvgpr_write_b32 a125, v243
    v_accvgpr_read_b32 v243, a126
    v_mul_f32 v243, v242, v243
    v_accvgpr_write_b32 a126, v243
    v_accvgpr_read_b32 v243, a127
    v_mul_f32 v243, v242, v243
    v_accvgpr_write_b32 a127, v243
    v_exp_f32 v241, v72
    v_exp_f32 v243, v73
    s_nop 0
    v_cvt_pk_bf16_f32 v100, v241, v243
    v_exp_f32 v241, v74
    v_exp_f32 v243, v75
    s_nop 0
    v_cvt_pk_bf16_f32 v101, v241, v243
    v_exp_f32 v241, v76
    v_exp_f32 v243, v77
    s_nop 0
    v_cvt_pk_bf16_f32 v102, v241, v243
    v_exp_f32 v241, v78
    v_exp_f32 v243, v79
    s_nop 0
    v_cvt_pk_bf16_f32 v103, v241, v243
    v_max3_f32 v240, v80, v81, v82
    v_max3_f32 v241, v83, v84, v85
    v_max3_f32 v240, v86, v87, v240
    v_max_f32 v240, v240, v241
    v_mov_b32 v241, v240
    s_nop 1
    v_permlane32_swap_b32 v240, v241
    v_max_f32 v240, v240, v241
    v_mov_b32 v241, v240
    s_nop 1
    v_permlane16_swap_b32 v240, v241
    v_max_f32 v240, v240, v241
    v_add_f32 v240, 1092616192, v240
    v_max_f32 v240, 0, v240
    v_sub_f32 v242, 0, v240
    v_exp_f32 v242, v242
    v_sub_f32 v80, v80, v240
    v_sub_f32 v81, v81, v240
    v_sub_f32 v82, v82, v240
    v_sub_f32 v83, v83, v240
    v_sub_f32 v84, v84, v240
    v_sub_f32 v85, v85, v240
    v_sub_f32 v86, v86, v240
    v_sub_f32 v87, v87, v240
    v_sub_f32 v124, v124, v240
    v_sub_f32 v125, v125, v240
    v_sub_f32 v126, v126, v240
    v_sub_f32 v127, v127, v240
    v_mul_f32 v144, v242, v144
    v_mul_f32 v145, v242, v145
    v_mul_f32 v146, v242, v146
    v_mul_f32 v147, v242, v147
    v_accvgpr_read_b32 v243, a128
    v_mul_f32 v243, v242, v243
    v_accvgpr_write_b32 a128, v243
    v_accvgpr_read_b32 v243, a129
    v_mul_f32 v243, v242, v243
    v_accvgpr_write_b32 a129, v243
    v_accvgpr_read_b32 v243, a130
    v_mul_f32 v243, v242, v243
    v_accvgpr_write_b32 a130, v243
    v_accvgpr_read_b32 v243, a131
    v_mul_f32 v243, v242, v243
    v_accvgpr_write_b32 a131, v243
    v_accvgpr_read_b32 v243, a132
    v_mul_f32 v243, v242, v243
    v_accvgpr_write_b32 a132, v243
    v_accvgpr_read_b32 v243, a133
    v_mul_f32 v243, v242, v243
    v_accvgpr_write_b32 a133, v243
    v_accvgpr_read_b32 v243, a134
    v_mul_f32 v243, v242, v243
    v_accvgpr_write_b32 a134, v243
    v_accvgpr_read_b32 v243, a135
    v_mul_f32 v243, v242, v243
    v_accvgpr_write_b32 a135, v243
    v_accvgpr_read_b32 v243, a136
    v_mul_f32 v243, v242, v243
    v_accvgpr_write_b32 a136, v243
    v_accvgpr_read_b32 v243, a137
    v_mul_f32 v243, v242, v243
    v_accvgpr_write_b32 a137, v243
    v_accvgpr_read_b32 v243, a138
    v_mul_f32 v243, v242, v243
    v_accvgpr_write_b32 a138, v243
    v_accvgpr_read_b32 v243, a139
    v_mul_f32 v243, v242, v243
    v_accvgpr_write_b32 a139, v243
    v_accvgpr_read_b32 v243, a140
    v_mul_f32 v243, v242, v243
    v_accvgpr_write_b32 a140, v243
    v_accvgpr_read_b32 v243, a141
    v_mul_f32 v243, v242, v243
    v_accvgpr_write_b32 a141, v243
    v_accvgpr_read_b32 v243, a142
    v_mul_f32 v243, v242, v243
    v_accvgpr_write_b32 a142, v243
    v_accvgpr_read_b32 v243, a143
    v_mul_f32 v243, v242, v243
    v_accvgpr_write_b32 a143, v243
    v_accvgpr_read_b32 v243, a144
    v_mul_f32 v243, v242, v243
    v_accvgpr_write_b32 a144, v243
    v_accvgpr_read_b32 v243, a145
    v_mul_f32 v243, v242, v243
    v_accvgpr_write_b32 a145, v243
    v_accvgpr_read_b32 v243, a146
    v_mul_f32 v243, v242, v243
    v_accvgpr_write_b32 a146, v243
    v_accvgpr_read_b32 v243, a147
    v_mul_f32 v243, v242, v243
    v_accvgpr_write_b32 a147, v243
    v_accvgpr_read_b32 v243, a148
    v_mul_f32 v243, v242, v243
    v_accvgpr_write_b32 a148, v243
    v_accvgpr_read_b32 v243, a149
    v_mul_f32 v243, v242, v243
    v_accvgpr_write_b32 a149, v243
    v_accvgpr_read_b32 v243, a150
    v_mul_f32 v243, v242, v243
    v_accvgpr_write_b32 a150, v243
    v_accvgpr_read_b32 v243, a151
    v_mul_f32 v243, v242, v243
    v_accvgpr_write_b32 a151, v243
    v_accvgpr_read_b32 v243, a152
    v_mul_f32 v243, v242, v243
    v_accvgpr_write_b32 a152, v243
    v_accvgpr_read_b32 v243, a153
    v_mul_f32 v243, v242, v243
    v_accvgpr_write_b32 a153, v243
    v_accvgpr_read_b32 v243, a154
    v_mul_f32 v243, v242, v243
    v_accvgpr_write_b32 a154, v243
    v_accvgpr_read_b32 v243, a155
    v_mul_f32 v243, v242, v243
    v_accvgpr_write_b32 a155, v243
    v_accvgpr_read_b32 v243, a156
    v_mul_f32 v243, v242, v243
    v_accvgpr_write_b32 a156, v243
    v_accvgpr_read_b32 v243, a157
    v_mul_f32 v243, v242, v243
    v_accvgpr_write_b32 a157, v243
    v_accvgpr_read_b32 v243, a158
    v_mul_f32 v243, v242, v243
    v_accvgpr_write_b32 a158, v243
    v_accvgpr_read_b32 v243, a159
    v_mul_f32 v243, v242, v243
    v_accvgpr_write_b32 a159, v243
    v_exp_f32 v241, v80
    v_exp_f32 v243, v81
    s_nop 0
    v_cvt_pk_bf16_f32 v104, v241, v243
    v_exp_f32 v241, v82
    v_exp_f32 v243, v83
    s_nop 0
    v_cvt_pk_bf16_f32 v105, v241, v243
    v_exp_f32 v241, v84
    v_exp_f32 v243, v85
    s_nop 0
    v_cvt_pk_bf16_f32 v106, v241, v243
    v_exp_f32 v241, v86
    v_exp_f32 v243, v87
    s_nop 0
    v_cvt_pk_bf16_f32 v107, v241, v243
    v_max3_f32 v240, v48, v49, v50
    v_max3_f32 v241, v51, v52, v53
    v_max3_f32 v240, v54, v55, v240
    v_max_f32 v240, v240, v241
    v_mov_b32 v241, v240
    s_nop 1
    v_permlane32_swap_b32 v240, v241
    v_max_f32 v240, v240, v241
    v_mov_b32 v241, v240
    s_nop 1
    v_permlane16_swap_b32 v240, v241
    v_max_f32 v240, v240, v241
    v_add_f32 v240, 1092616192, v240
    v_max_f32 v240, 0, v240
    v_sub_f32 v242, 0, v240
    v_exp_f32 v242, v242
    v_sub_f32 v48, v48, v240
    v_sub_f32 v49, v49, v240
    v_sub_f32 v50, v50, v240
    v_sub_f32 v51, v51, v240
    v_sub_f32 v52, v52, v240
    v_sub_f32 v53, v53, v240
    v_sub_f32 v54, v54, v240
    v_sub_f32 v55, v55, v240
    v_sub_f32 v108, v108, v240
    v_sub_f32 v109, v109, v240
    v_sub_f32 v110, v110, v240
    v_sub_f32 v111, v111, v240
    v_mul_f32 v128, v242, v128
    v_mul_f32 v129, v242, v129
    v_mul_f32 v130, v242, v130
    v_mul_f32 v131, v242, v131
    v_accvgpr_read_b32 v243, a0
    v_mul_f32 v243, v242, v243
    v_accvgpr_write_b32 a0, v243
    v_accvgpr_read_b32 v243, a1
    v_mul_f32 v243, v242, v243
    v_accvgpr_write_b32 a1, v243
    v_accvgpr_read_b32 v243, a2
    v_mul_f32 v243, v242, v243
    v_accvgpr_write_b32 a2, v243
    v_accvgpr_read_b32 v243, a3
    v_mul_f32 v243, v242, v243
    v_accvgpr_write_b32 a3, v243
    v_accvgpr_read_b32 v243, a4
    v_mul_f32 v243, v242, v243
    v_accvgpr_write_b32 a4, v243
    v_accvgpr_read_b32 v243, a5
    v_mul_f32 v243, v242, v243
    v_accvgpr_write_b32 a5, v243
    v_accvgpr_read_b32 v243, a6
    v_mul_f32 v243, v242, v243
    v_accvgpr_write_b32 a6, v243
    v_accvgpr_read_b32 v243, a7
    v_mul_f32 v243, v242, v243
    v_accvgpr_write_b32 a7, v243
    v_accvgpr_read_b32 v243, a8
    v_mul_f32 v243, v242, v243
    v_accvgpr_write_b32 a8, v243
    v_accvgpr_read_b32 v243, a9
    v_mul_f32 v243, v242, v243
    v_accvgpr_write_b32 a9, v243
    v_accvgpr_read_b32 v243, a10
    v_mul_f32 v243, v242, v243
    v_accvgpr_write_b32 a10, v243
    v_accvgpr_read_b32 v243, a11
    v_mul_f32 v243, v242, v243
    v_accvgpr_write_b32 a11, v243
    v_accvgpr_read_b32 v243, a12
    v_mul_f32 v243, v242, v243
    v_accvgpr_write_b32 a12, v243
    v_accvgpr_read_b32 v243, a13
    v_mul_f32 v243, v242, v243
    v_accvgpr_write_b32 a13, v243
    v_accvgpr_read_b32 v243, a14
    v_mul_f32 v243, v242, v243
    v_accvgpr_write_b32 a14, v243
    v_accvgpr_read_b32 v243, a15
    v_mul_f32 v243, v242, v243
    v_accvgpr_write_b32 a15, v243
    v_accvgpr_read_b32 v243, a16
    v_mul_f32 v243, v242, v243
    v_accvgpr_write_b32 a16, v243
    v_accvgpr_read_b32 v243, a17
    v_mul_f32 v243, v242, v243
    v_accvgpr_write_b32 a17, v243
    v_accvgpr_read_b32 v243, a18
    v_mul_f32 v243, v242, v243
    v_accvgpr_write_b32 a18, v243
    v_accvgpr_read_b32 v243, a19
    v_mul_f32 v243, v242, v243
    v_accvgpr_write_b32 a19, v243
    v_accvgpr_read_b32 v243, a20
    v_mul_f32 v243, v242, v243
    v_accvgpr_write_b32 a20, v243
    v_accvgpr_read_b32 v243, a21
    v_mul_f32 v243, v242, v243
    v_accvgpr_write_b32 a21, v243
    v_accvgpr_read_b32 v243, a22
    v_mul_f32 v243, v242, v243
    v_accvgpr_write_b32 a22, v243
    v_accvgpr_read_b32 v243, a23
    v_mul_f32 v243, v242, v243
    v_accvgpr_write_b32 a23, v243
    v_accvgpr_read_b32 v243, a24
    v_mul_f32 v243, v242, v243
    v_accvgpr_write_b32 a24, v243
    v_accvgpr_read_b32 v243, a25
    v_mul_f32 v243, v242, v243
    v_accvgpr_write_b32 a25, v243
    v_accvgpr_read_b32 v243, a26
    v_mul_f32 v243, v242, v243
    v_accvgpr_write_b32 a26, v243
    v_accvgpr_read_b32 v243, a27
    v_mul_f32 v243, v242, v243
    v_accvgpr_write_b32 a27, v243
    v_accvgpr_read_b32 v243, a28
    v_mul_f32 v243, v242, v243
    v_accvgpr_write_b32 a28, v243
    v_accvgpr_read_b32 v243, a29
    v_mul_f32 v243, v242, v243
    v_accvgpr_write_b32 a29, v243
    v_accvgpr_read_b32 v243, a30
    v_mul_f32 v243, v242, v243
    v_accvgpr_write_b32 a30, v243
    v_accvgpr_read_b32 v243, a31
    v_mul_f32 v243, v242, v243
    v_accvgpr_write_b32 a31, v243
    v_exp_f32 v241, v48
    v_exp_f32 v243, v49
    s_nop 0
    v_cvt_pk_bf16_f32 v88, v241, v243
    v_exp_f32 v241, v50
    v_exp_f32 v243, v51
    s_nop 0
    v_cvt_pk_bf16_f32 v89, v241, v243
    v_exp_f32 v241, v52
    v_exp_f32 v243, v53
    s_nop 0
    v_cvt_pk_bf16_f32 v90, v241, v243
    v_exp_f32 v241, v54
    v_exp_f32 v243, v55
    s_nop 0
    v_cvt_pk_bf16_f32 v91, v241, v243
    s_nop 3
    s_cmp_eq_u32 s72, 2
    s_cbranch_scc1 L_RET2
    s_branch L_RET4
L_TEXT_END:
.section .rodata,"a"
.p2align 6
.amdhsa_kernel concat_heads__gqa_block_cached__gqa_block_cached__near_ridge_kernel
  .amdhsa_next_free_vgpr 512
  .amdhsa_next_free_sgpr 102
  .amdhsa_accum_offset 256
  .amdhsa_group_segment_fixed_size 0
  .amdhsa_kernarg_size 104
  .amdhsa_user_sgpr_count 2
  .amdhsa_user_sgpr_kernarg_segment_ptr 1
  .amdhsa_system_sgpr_workgroup_id_x 1
.end_amdhsa_kernel
.text
```
